```python
import torch

def _softmax(x, axis=-1):
    return torch.softmax(x, dim=axis)
def _gelu(x):
    return torch.nn.functional.gelu(x, approximate="tanh")
def _silu(x):
    return torch.nn.functional.silu(x)
def _sigmoid(x):
    return torch.sigmoid(x)
def _layernorm(x, axis=-1, eps=1e-5):
    m = x.mean(dim=axis, keepdim=True)
    v = x.var(dim=axis, keepdim=True, unbiased=False)
    return (x - m) / torch.sqrt(v + eps)
def _scatter_add(tgt, idx, src, axis=0):
    return tgt.clone().index_add_(axis, idx, src)
def _segment_sum(src, seg, n):
    out = torch.zeros((n,) + src.shape[1:], dtype=src.dtype)
    return out.index_add_(0, seg, src)
def _pad(x, pw):
    flat = tuple(v for pair in reversed(pw) for v in pair)
    return torch.nn.functional.pad(x, flat)

kernel_name = 'standalone__edge_featured_mpnn_gatedgcn__graph'

def setup_inputs():

    _w = (lambda a: (lambda t: t.to(torch.bfloat16) if t.is_floating_point() else t)(torch.as_tensor(a)))
    N, deg, D, De = 10000, 16, 256, max(0, 1)
    E = N * deg
    return {
        "x": _w((lambda *s: torch.randn(*s, dtype=torch.bfloat16) * 0.4)(N, D)),
        "e_attr": _w((lambda *s: torch.randn(*s, dtype=torch.bfloat16) * 0.8)(E, De)),
        "src": _w((lambda lo, hi, *s: torch.randint(lo, hi, s))(0, N, E).to(torch.int64)),
        "dst": _w((lambda lo, hi, *s: torch.randint(lo, hi, s))(0, N, E).to(torch.int64)),
        "w_a": _w((lambda *s: torch.randn(*s, dtype=torch.bfloat16) * 0.4)(D, D)),
        "w_b": _w((lambda *s: torch.randn(*s, dtype=torch.bfloat16) * 0.4)(D, D)),
        "w_c": _w((lambda *s: torch.randn(*s, dtype=torch.bfloat16) * 0.8)(De, D)),
        "w_u": _w((lambda *s: torch.randn(*s, dtype=torch.bfloat16) * 0.05)(D, D)),
        "w_v": _w((lambda *s: torch.randn(*s, dtype=torch.bfloat16) * 0.05)(D, D)),
    }

def reference(x, e_attr, src, dst, w_a, w_b, w_c, w_u, w_v):
    N, D = x.shape
    hv = x @ w_v
    g = x[dst] @ w_a + x[src] @ w_b + e_attr @ w_c
    eta = _sigmoid(g)
    denom = _segment_sum(eta, dst, N) + 1e-6
    eta_n = eta / denom[dst]
    agg = _segment_sum(eta_n * hv[src], dst, N)
    z = x @ w_u + agg
    relu_z = torch.where(z > 0, z, 0 * z)
    return x + relu_z
```

```asm
; @launch grid=(256,1,1) block=(1024,1,1) lds=163840
.amdgcn_target "amdgcn-amd-amdhsa--gfx950"
.text
.globl standalone__edge_featured_mpnn_gatedgcn__graph_kernel
.p2align 8
.type standalone__edge_featured_mpnn_gatedgcn__graph_kernel,@function
standalone__edge_featured_mpnn_gatedgcn__graph_kernel:
  s_cmp_ge_u32 s2, 256
  s_cbranch_scc1 K_END
  s_load_dwordx16 s[16:31], s[0:1], 0
  s_load_dwordx8 s[32:39], s[0:1], 64
  v_lshrrev_b32 v2, 6, v0
  v_and_b32 v1, 63, v0
  v_readfirstlane_b32 s3, v2
  s_and_b32 s4, s2, 3
  s_lshr_b32 s5, s2, 2
  s_mul_i32 s6, s5, 80384
  v_mov_b32 v3, 0
  v_lshlrev_b32 v57, 4, v0
  s_cmp_gt_u32 s3, 4
  s_cbranch_scc1 K_OTH
  s_cmp_eq_u32 s3, 4
  s_cbranch_scc1 K_LD
  s_mul_i32 s8, s3, 40
  v_add_u32 v2, s8, v1
  v_lshlrev_b32 v6, 4, v2
  v_lshlrev_b32 v7, 3, v2
  s_mul_i32 s8, s2, 2560
  s_mul_i32 s9, s2, 1280
  s_mov_b32 s62, 640000
  s_mov_b32 s63, 0x20000
  s_mov_b32 s66, 640000
  s_mov_b32 s67, 0x20000
  s_mov_b32 s70, 320000
  s_mov_b32 s71, 0x20000
  v_cmp_gt_u32 vcc, 224, v0
  v_mov_b32 v8, -1
  v_mov_b32 v9, -1
  v_mov_b32 v10, -1
  v_mov_b32 v11, -1
  v_mov_b32 v16, 10240
  v_cndmask_b32 v12, 0, v16, vcc
  v_mov_b32 v13, v12
  v_mov_b32 v14, v12
  v_mov_b32 v15, v12
  s_mov_b32 exec_hi, 255
  s_waitcnt lgkmcnt(0)
  s_mov_b64 s[60:61], s[22:23]
  s_mov_b64 s[64:65], s[20:21]
  s_mov_b64 s[68:69], s[18:19]
  buffer_load_dwordx4 v[64:67], v6, s[60:63], s8 offen
  buffer_load_dwordx4 v[68:71], v6, s[64:67], s8 offen
  buffer_load_dwordx2 v[72:73], v7, s[68:71], s9 offen
  s_mov_b32 exec_hi, -1
  s_mov_b32 s12, 13959168
  ds_write_b128 v57, v[12:15] offset:12288
  ds_write_b128 v57, v[8:11]
  ds_write_b128 v57, v[8:11] offset:4096
  ds_write_b128 v57, v[8:11] offset:8192
  s_waitcnt lgkmcnt(0)
  s_load_dword s81, s[38:39], s12
  s_barrier
  s_branch K_SETUP
K_LD:
  s_setprio 3
  v_lshrrev_b32 v2, 5, v1
  v_and_b32 v4, 31, v1
  v_xor_b32 v4, v2, v4
  v_lshlrev_b32 v4, 4, v4
  v_lshl_add_u32 v8, v2, 9, v4
  v_xor_b32 v9, 32, v8
  v_xor_b32 v10, 64, v8
  v_xor_b32 v11, 64, v9
  v_xor_b32 v12, 0x1080, v8
  v_xor_b32 v13, 32, v12
  v_xor_b32 v14, 64, v12
  v_xor_b32 v15, 64, v13
  s_mov_b32 s42, 5120000
  s_mov_b32 s43, 0x20000
  s_mov_b32 s10, 16384
  s_mov_b32 s9, s6
  s_mov_b32 s11, -5
  s_mov_b32 s13, 40960
  s_cmp_eq_u32 s3, 14
  s_waitcnt lgkmcnt(0)
  s_mov_b64 s[40:41], s[16:17]
  s_cbranch_scc1 K_W14
K_LX:
  s_mov_b32 m0, s10
  s_nop 0
  buffer_load_dwordx4 v8, s[40:43], s9 offen offset:0 lds
  buffer_load_dwordx4 v9, s[40:43], s9 offen offset:1024 lds
  buffer_load_dwordx4 v10, s[40:43], s9 offen offset:2048 lds
  buffer_load_dwordx4 v11, s[40:43], s9 offen offset:3072 lds
  s_add_u32 m0, s10, 4096
  s_nop 0
  buffer_load_dwordx4 v12, s[40:43], s9 offen offset:0 lds
  buffer_load_dwordx4 v13, s[40:43], s9 offen offset:1024 lds
  buffer_load_dwordx4 v14, s[40:43], s9 offen offset:2048 lds
  buffer_load_dwordx4 v15, s[40:43], s9 offen offset:3072 lds
  s_cmp_lg_u32 s10, 16384
  s_cbranch_scc1 K_LX1
  s_mov_b64 s[48:49], s[26:27]
  s_mov_b64 s[50:51], s[32:33]
  v_mov_b32 v20, 0
  s_mov_b32 s14, s4
  s_lshr_b32 s7, s5, 1
K_LWA:
  v_lshrrev_b32 v2, 3, v1
  v_and_b32 v5, 7, v1
  v_and_b32 v4, 2, v2
  v_xor_b32 v5, v5, v4
  v_lshlrev_b32 v5, 4, v5
  v_lshl_add_u32 v5, v2, 9, v5
  s_lshl_b32 s8, s14, 7
  v_add_u32 v16, s8, v5
  v_xor_b32 v17, 64, v16
  v_add_u32 v17, 3072, v17
  v_add_u32 v18, 6144, v16
  v_add_u32 v19, 6144, v17
  s_add_u32 s15, s7, 8
  s_mov_b32 s46, 131072
  s_mov_b32 s47, 0x20000
  s_barrier
  s_cmp_eq_u32 s3, 14
  s_cbranch_scc1 K_W2W
K_LX1:
  s_add_u32 s10, s10, 8192
  s_add_u32 s9, s9, 8192
  s_add_u32 s11, s11, 1
  v_mov_b32 v2, s11
  s_mov_b64 exec, 1
  s_waitcnt vmcnt(40)
  ds_write_b32 v20, v2 offset:16160
  s_mov_b64 exec, -1
  s_cmp_lt_u32 s10, s13
  s_cbranch_scc1 K_LX
  s_cmp_eq_u32 s7, s15
  s_cbranch_scc1 K_LDR
K_LW:
  s_bitcmp1_b32 s7, 2
  s_cselect_b64 s[44:45], s[50:51], s[48:49]
  s_and_b32 s8, s7, 7
  s_lshl_b32 s8, s8, 13
  s_add_u32 m0, s8, 98304
  s_and_b32 s12, s7, 3
  s_lshl_b32 s12, s12, 15
  buffer_load_dwordx4 v16, s[44:47], s12 offen offset:0 lds
  buffer_load_dwordx4 v17, s[44:47], s12 offen offset:1024 lds
  buffer_load_dwordx4 v18, s[44:47], s12 offen offset:2048 lds
  buffer_load_dwordx4 v19, s[44:47], s12 offen offset:3072 lds
  s_add_u32 m0, m0, 4096
  s_add_u32 s12, s12, 16384
  buffer_load_dwordx4 v16, s[44:47], s12 offen offset:0 lds
  buffer_load_dwordx4 v17, s[44:47], s12 offen offset:1024 lds
  buffer_load_dwordx4 v18, s[44:47], s12 offen offset:2048 lds
  buffer_load_dwordx4 v19, s[44:47], s12 offen offset:3072 lds
  s_add_u32 s7, s7, 1
  s_add_u32 s11, s11, 1
  v_mov_b32 v2, s11
  s_mov_b64 exec, 1
  s_waitcnt vmcnt(40)
  ds_write_b32 v20, v2 offset:16160
  s_mov_b64 exec, -1
  s_cmp_lt_u32 s7, s15
  s_cbranch_scc1 K_LW
  s_mov_b32 s13, 98304
  s_cmp_eq_u32 s3, 4
  s_cbranch_scc1 K_LX
  s_waitcnt vmcnt(0)
  s_mov_b32 s80, 0x400000
K_W2X:
  ds_read_b32 v4, v3 offset:16160
  s_waitcnt lgkmcnt(0)
  v_readfirstlane_b32 s8, v4
  s_cmp_ge_i32 s8, 18
  s_cbranch_scc1 K_W2X_D
  s_sub_u32 s80, s80, 1
  s_cbranch_scc0 K_W2X
K_W2X_D:
  v_mov_b32 v2, 40
  s_mov_b64 exec, 1
  ds_write_b32 v3, v2 offset:16200
  s_mov_b64 exec, -1
  s_setprio 0
  s_branch K_SETUP
K_W2W:
  s_bitcmp1_b32 s7, 4
  s_cselect_b64 s[44:45], s[50:51], s[48:49]
  s_and_b32 s12, s7, 15
  s_lshl_b32 s12, s12, 13
  s_lshl_b32 s8, s4, 7
  s_add_u32 s12, s12, s8
  v_lshlrev_b32 v2, 9, v1
  s_mov_b64 exec, 0xffff
  buffer_load_dword v0, v2, s[44:47], s12 offen
  s_mov_b64 exec, -1
  s_mov_b32 s80, 0x400000
K_W2R:
  ds_read_b32 v4, v3 offset:16160
  s_waitcnt lgkmcnt(0)
  v_readfirstlane_b32 s8, v4
  s_cmp_ge_i32 s8, 12
  s_cbranch_scc1 K_W2R_D
  s_sleep 2
  s_sub_u32 s80, s80, 1
  s_cbranch_scc0 K_W2R
K_W2R_D:
  s_mov_b32 s80, 0x400000
K_LWC:
  ds_read_b32 v4, v3 offset:16164
  s_waitcnt lgkmcnt(0)
  v_readfirstlane_b32 s8, v4
  s_cmp_ge_u32 s8, 4
  s_cbranch_scc1 K_LWC_D
  s_sub_u32 s80, s80, 1
  s_cbranch_scc0 K_LWC
K_LWC_D:
  s_branch K_LW
K_LDR:
  s_mov_b64 exec, 1
  s_add_u32 s11, s11, 1
  v_mov_b32 v2, s11
  s_waitcnt vmcnt(32)
  ds_write_b32 v3, v2 offset:16160
  s_add_u32 s11, s11, 1
  v_mov_b32 v2, s11
  s_waitcnt vmcnt(24)
  ds_write_b32 v3, v2 offset:16160
  s_add_u32 s11, s11, 1
  v_mov_b32 v2, s11
  s_waitcnt vmcnt(16)
  ds_write_b32 v3, v2 offset:16160
  s_add_u32 s11, s11, 1
  v_mov_b32 v2, s11
  s_waitcnt vmcnt(8)
  ds_write_b32 v3, v2 offset:16160
  s_add_u32 s11, s11, 1
  v_mov_b32 v2, s11
  s_waitcnt vmcnt(0)
  ds_write_b32 v3, v2 offset:16160
  s_mov_b64 exec, -1
  s_setprio 0
  s_branch K_SETUP
K_W14:
  s_mov_b64 s[48:49], s[24:25]
  s_mov_b64 s[50:51], s[30:31]
  v_mov_b32 v20, 40
  s_mov_b32 s11, 0
  s_mov_b32 s14, s4
  s_lshr_b32 s7, s5, 1
  s_branch K_LWA
K_OTH:
  s_cmp_eq_u32 s3, 14
  s_cbranch_scc1 K_LD
  s_cmp_lg_u32 s3, 5
  s_cbranch_scc1 K_NCPF
  s_getpc_b64 s[8:9]
K_PC0:
  s_bfe_u32 s12, s2, 0x20003
  s_lshl_b32 s12, s12, 13
  v_lshlrev_b32 v4, 7, v1
  v_add_u32 v4, s12, v4
  v_min_u32 v4, K_CODE_END-K_PC0-64, v4
  v_mov_b32 v5, s9
  v_add_co_u32 v4, vcc, s8, v4
  s_nop 1
  v_addc_co_u32 v5, vcc, 0, v5, vcc
  global_load_dword v0, v[4:5], off
K_NCPF:
  s_waitcnt lgkmcnt(0)
  s_barrier
K_SETUP:
  s_and_b32 s7, s3, 3
  s_mov_b32 s72, 3216550459
  s_mov_b32 s73, 3216550459
  s_mov_b32 s74, 1199570944
  s_mov_b32 s75, 1199570944
  s_mov_b32 s76, 897988541
  s_mov_b32 s77, 897988541
  s_mov_b32 s78, 0xffff0000
  s_mov_b32 s79, 0x07060302
  s_mov_b64 s[82:83], 0
  s_mul_i32 s14, s4, 2686976
  s_add_u32 s60, s38, s14
  s_addc_u32 s61, s39, 0
  s_or_b32 s61, s61, 0x1000000
  s_mov_b32 s62, 10240
  s_mov_b32 s63, 0x20000
  s_lshl_b32 s59, s4, 13
  s_add_u32 s59, s59, 13926400
  v_mov_b32 v2, 1
  s_mov_b64 s[52:53], s[38:39]
  s_mov_b32 s54, 268435456
  s_mov_b32 s55, 0x20000
  s_mov_b64 s[64:65], s[34:35]
  s_mov_b32 s66, 5120000
  s_mov_b32 s67, 0x20000
  s_mov_b64 s[68:69], s[28:29]
  s_mov_b32 s70, 512
  s_mov_b32 s71, 0x20000
  s_cmp_eq_u32 s3, 15
  s_cbranch_scc1 K_H15
  s_cmp_ge_u32 s3, 13
  s_cbranch_scc1 K_PA13
  s_cmp_gt_u32 s3, 4
  s_cbranch_scc1 K_GM
  s_cmp_eq_u32 s3, 4
  s_cbranch_scc1 K_PAR
  s_setprio 3
  s_movk_i32 s8, -157
  s_waitcnt lgkmcnt(0)
  s_add_u32 s81, s81, 0x9e3779b1
  v_and_b32 v4, 3, v1
  v_lshlrev_b32 v6, 3, v4
  v_lshrrev_b32 v42, v6, s81
  v_lshlrev_b32 v42, 24, v42
  v_or_b32 v42, 0xffffff, v42
  v_lshrrev_b32 v45, 3, v1
  v_mul_u32_u24 v45, 12288, v45
  v_and_b32 v6, 7, v1
  v_lshl_add_u32 v43, v6, 4, v45
  v_lshl_add_u32 v45, v4, 4, v45
  v_mov_b32 v44, v45
  s_cmp_ge_u32 s2, 250
  s_waitcnt vmcnt(0)
  s_cbranch_scc1 K_PSYNC
  s_mov_b32 exec_hi, 255
  v_mul_u32_u24 v76, 13358, v64
  v_lshrrev_b32 v76, 21, v76
  v_lshlrev_b32 v4, 2, v76
  ds_add_rtn_u32 v80, v4, v2 offset:15872
  v_mad_i32_i24 v64, v76, s8, v64
  v_lshl_or_b32 v68, v72, 16, v68
  v_mul_u32_u24 v77, 13358, v65
  v_lshrrev_b32 v77, 21, v77
  v_lshlrev_b32 v4, 2, v77
  ds_add_rtn_u32 v81, v4, v2 offset:15872
  v_mad_i32_i24 v65, v77, s8, v65
  v_and_or_b32 v69, v72, s78, v69
  v_mul_u32_u24 v78, 13358, v66
  v_lshrrev_b32 v78, 21, v78
  v_lshlrev_b32 v4, 2, v78
  ds_add_rtn_u32 v82, v4, v2 offset:15872
  v_mad_i32_i24 v66, v78, s8, v66
  v_lshl_or_b32 v70, v73, 16, v70
  v_mul_u32_u24 v79, 13358, v67
  v_lshrrev_b32 v79, 21, v79
  v_lshlrev_b32 v4, 2, v79
  ds_add_rtn_u32 v83, v4, v2 offset:15872
  v_mad_i32_i24 v67, v79, s8, v67
  v_and_or_b32 v71, v73, s78, v71
  v_lshlrev_b32 v76, 7, v76
  v_lshlrev_b32 v77, 7, v77
  v_lshlrev_b32 v78, 7, v78
  v_lshlrev_b32 v79, 7, v79
  s_waitcnt lgkmcnt(3)
  v_and_b32 v4, 7, v80
  v_lshl_add_u32 v84, v4, 4, v76
  v_lshrrev_b32 v88, 3, v80
  s_waitcnt lgkmcnt(2)
  v_and_b32 v4, 7, v81
  v_lshl_add_u32 v85, v4, 4, v77
  v_lshrrev_b32 v89, 3, v81
  s_waitcnt lgkmcnt(1)
  v_and_b32 v4, 7, v82
  v_lshl_add_u32 v86, v4, 4, v78
  v_lshrrev_b32 v90, 3, v82
  s_waitcnt lgkmcnt(0)
  v_and_b32 v4, 7, v83
  v_lshl_add_u32 v87, v4, 4, v79
  v_lshrrev_b32 v91, 3, v83
  v_max3_u32 v4, v88, v89, v90
  v_max_u32 v4, v4, v91
  v_cmp_lt_u32 vcc, 2, v4
  s_cbranch_vccnz K_PFIX
K_PFB:
  v_add_u32 v6, v84, v88
  v_lshl_add_u32 v4, v88, 2, v84
  ds_write_b8 v6, v64 offset:12
  ds_write_b32 v4, v68
  v_add_u32 v6, v85, v89
  v_lshl_add_u32 v4, v89, 2, v85
  ds_write_b8 v6, v65 offset:12
  ds_write_b32 v4, v69
  v_add_u32 v6, v86, v90
  v_lshl_add_u32 v4, v90, 2, v86
  ds_write_b8 v6, v66 offset:12
  ds_write_b32 v4, v70
  v_add_u32 v6, v87, v91
  v_lshl_add_u32 v4, v91, 2, v87
  ds_write_b8 v6, v67 offset:12
  ds_write_b32 v4, v71
K_PSYNC:
  s_mov_b64 exec, 1
  ds_add_u32 v3, v2 offset:16192
  s_or_b32 s8, s81, 3
  v_mov_b32 v7, s8
  ds_write_b32 v3, v7 offset:16172
  s_mov_b64 exec, -1
  s_mul_i32 s8, s2, 12288
  s_add_u32 s8, s8, 10747904
  s_add_u32 s13, s8, 4096
  s_add_u32 s9, s8, 8192
  v_lshlrev_b32 v6, 2, v1
  s_mov_b32 s80, 0x400000
K_PW:
  ds_read_b32 v4, v3 offset:16192
  ds_read_b128 v[64:67], v57
  ds_read_b128 v[68:71], v57 offset:4096
  ds_read_b32 v7, v6 offset:15872
  s_sub_u32 s80, s80, 1
  s_cbranch_scc1 K_PW1
  s_waitcnt lgkmcnt(3)
  v_readfirstlane_b32 s12, v4
  s_cmp_lg_u32 s12, 4
  s_cbranch_scc1 K_PW
K_PW1:
  s_waitcnt lgkmcnt(0)
  v_and_b32 v67, v67, v42
  v_and_b32 v71, v71, v42
  v_cmp_lt_u32 vcc, 23, v7
  buffer_store_dwordx4 v[64:67], v57, s[52:55], s8 offen sc1
  buffer_store_dwordx4 v[68:71], v57, s[52:55], s13 offen sc1
  s_cbranch_vccnz K_POV
K_POB:
  v_cmp_eq_u32 vcc, 0xff0, v57
  v_mov_b32 v13, 16320
  v_mov_b32 v17, v16
  v_cndmask_b32 v12, 0, v13, vcc
  v_mov_b32 v13, v12
  v_mov_b32 v14, v12
  v_mov_b32 v15, v12
  v_mov_b32 v18, v16
  v_mov_b32 v19, v16
  ds_write_b128 v57, v[12:15]
  ds_write_b128 v57, v[16:19] offset:4096
  ds_write_b128 v57, v[16:19] offset:8192
  s_mov_b64 exec, 1
  ds_add_u32 v3, v2 offset:16188
  s_mov_b64 exec, -1
  s_mul_i32 s9, s3, 786432
  s_add_u32 s9, s9, 10747904
  s_lshl_b32 s8, s5, 6
  s_add_u32 s58, s9, s8
  s_add_u32 s40, s58, s8
  s_add_u32 s58, s58, 8192
  s_mov_b64 s[56:57], 0
  s_mov_b32 s48, 0x80808080
  s_mov_b32 s49, 0x80808080
  s_movk_i32 s10, 0xff0
  s_mov_b32 s11, 65536
  v_mov_b32 v99, v42
  s_setprio 0
  s_add_u32 s41, s40, 98304
  s_add_u32 s42, s40, 196608
  s_add_u32 s43, s40, 294912
  s_add_u32 s44, s40, 393216
  s_add_u32 s45, s40, 491520
  s_add_u32 s46, s40, 589824
  s_add_u32 s47, s40, 688128
  v_mov_b64 v[8:9], 0
  v_mov_b64 v[10:11], 0
  v_mov_b64 v[12:13], 0
  v_mov_b64 v[14:15], 0
  v_mov_b64 v[16:17], 0
  v_mov_b64 v[18:19], 0
  v_mov_b64 v[20:21], 0
  v_mov_b64 v[22:23], 0
  v_mov_b64 v[24:25], 0
  v_mov_b64 v[26:27], 0
  v_mov_b64 v[28:29], 0
  v_mov_b64 v[30:31], 0
  v_mov_b64 v[32:33], 0
  v_mov_b32 v34, 0
  v_mov_b32 v47, 0xffc
  v_mov_b32 v48, 0
  s_mov_b64 s[50:51], 0
  s_mov_b32 s15, 0
  s_mov_b32 s80, 0x400000
K_RDL:
  ds_read_b32 v4, v3 offset:16160
  s_waitcnt lgkmcnt(0)
  v_readfirstlane_b32 s8, v4
  s_cmp_ge_i32 s8, 14
  s_cbranch_scc1 K_RDL_D
  s_sleep 2
  s_sub_u32 s80, s80, 1
  s_cbranch_scc0 K_RDL
K_RDL_D:
  s_setprio 3
  buffer_load_dwordx4 v[64:67], v43, s[52:55], s40 offen sc1
  buffer_load_dwordx4 v[68:71], v43, s[52:55], s41 offen sc1
  buffer_load_dwordx4 v[72:75], v43, s[52:55], s42 offen sc1
  buffer_load_dwordx4 v[76:79], v43, s[52:55], s43 offen sc1
  buffer_load_dwordx4 v[80:83], v43, s[52:55], s44 offen sc1
  buffer_load_dwordx4 v[84:87], v43, s[52:55], s45 offen sc1
  buffer_load_dwordx4 v[88:91], v43, s[52:55], s46 offen sc1
  buffer_load_dwordx4 v[92:95], v43, s[52:55], s47 offen sc1
  s_mov_b32 s80, 0x400000
K_PUBW:
  ds_read_b32 v4, v3 offset:16188
  s_waitcnt lgkmcnt(0)
  v_readfirstlane_b32 s8, v4
  s_cmp_ge_u32 s8, 4
  s_cbranch_scc1 K_PUBW_D
  s_sub_u32 s80, s80, 1
  s_cbranch_scc0 K_PUBW
K_PUBW_D:
  s_waitcnt vmcnt(7)
K_C0:
  v_cmp_ne_u32_sdwa vcc, v67, v42 src0_sel:WORD_1 src1_sel:WORD_1
  v_lshlrev_b32_sdwa v35, 4, v67 dst_sel:DWORD dst_unused:UNUSED_PAD src0_sel:DWORD src1_sel:BYTE_0
  v_lshlrev_b32_sdwa v36, 4, v67 dst_sel:DWORD dst_unused:UNUSED_PAD src0_sel:DWORD src1_sel:BYTE_1
  v_and_or_b32 v35, v64, 12, v35
  v_and_or_b32 v36, v65, 12, v36
  s_cbranch_vccnz K_S0
K_D0:
  v_cmpx_gt_u32 vcc, s10, v35
  ds_add_rtn_u32 v8, v35, v2 offset:0
  v_cmpx_gt_u32 vcc, s10, v36
  ds_add_rtn_u32 v9, v36, v2 offset:0
K_RK0:
  s_mov_b64 exec, -1
  s_waitcnt vmcnt(6)
K_C1:
  v_cmp_ne_u32_sdwa vcc, v71, v42 src0_sel:WORD_1 src1_sel:WORD_1
  v_lshlrev_b32_sdwa v38, 4, v71 dst_sel:DWORD dst_unused:UNUSED_PAD src0_sel:DWORD src1_sel:BYTE_0
  v_lshlrev_b32_sdwa v39, 4, v71 dst_sel:DWORD dst_unused:UNUSED_PAD src0_sel:DWORD src1_sel:BYTE_1
  v_and_or_b32 v38, v68, 12, v38
  v_and_or_b32 v39, v69, 12, v39
  s_cbranch_vccnz K_S1
K_D1:
  v_cmpx_gt_u32 vcc, s10, v38
  ds_add_rtn_u32 v11, v38, v2 offset:0
  v_cmpx_gt_u32 vcc, s10, v39
  ds_add_rtn_u32 v12, v39, v2 offset:0
K_RK1:
  s_mov_b64 exec, -1
  s_waitcnt vmcnt(5)
K_C2:
  v_cmp_ne_u32_sdwa vcc, v75, v42 src0_sel:WORD_1 src1_sel:WORD_1
  v_lshlrev_b32_sdwa v41, 4, v75 dst_sel:DWORD dst_unused:UNUSED_PAD src0_sel:DWORD src1_sel:BYTE_0
  v_lshlrev_b32_sdwa v100, 4, v75 dst_sel:DWORD dst_unused:UNUSED_PAD src0_sel:DWORD src1_sel:BYTE_1
  v_and_or_b32 v41, v72, 12, v41
  v_and_or_b32 v100, v73, 12, v100
  s_cbranch_vccnz K_S2
K_D2:
  v_cmpx_gt_u32 vcc, s10, v41
  ds_add_rtn_u32 v14, v41, v2 offset:0
  v_cmpx_gt_u32 vcc, s10, v100
  ds_add_rtn_u32 v15, v100, v2 offset:0
K_RK2:
  s_mov_b64 exec, -1
  s_waitcnt vmcnt(4)
K_C3:
  v_cmp_ne_u32_sdwa vcc, v79, v42 src0_sel:WORD_1 src1_sel:WORD_1
  v_lshlrev_b32_sdwa v102, 4, v79 dst_sel:DWORD dst_unused:UNUSED_PAD src0_sel:DWORD src1_sel:BYTE_0
  v_lshlrev_b32_sdwa v103, 4, v79 dst_sel:DWORD dst_unused:UNUSED_PAD src0_sel:DWORD src1_sel:BYTE_1
  v_and_or_b32 v102, v76, 12, v102
  v_and_or_b32 v103, v77, 12, v103
  s_cbranch_vccnz K_S3
K_D3:
  v_cmpx_gt_u32 vcc, s10, v102
  ds_add_rtn_u32 v17, v102, v2 offset:0
  v_cmpx_gt_u32 vcc, s10, v103
  ds_add_rtn_u32 v18, v103, v2 offset:0
K_RK3:
  s_mov_b64 exec, -1
  s_waitcnt vmcnt(3)
K_C4:
  v_cmp_ne_u32_sdwa vcc, v83, v42 src0_sel:WORD_1 src1_sel:WORD_1
  v_lshlrev_b32_sdwa v105, 4, v83 dst_sel:DWORD dst_unused:UNUSED_PAD src0_sel:DWORD src1_sel:BYTE_0
  v_lshlrev_b32_sdwa v106, 4, v83 dst_sel:DWORD dst_unused:UNUSED_PAD src0_sel:DWORD src1_sel:BYTE_1
  v_and_or_b32 v105, v80, 12, v105
  v_and_or_b32 v106, v81, 12, v106
  s_cbranch_vccnz K_S4
K_D4:
  v_cmpx_gt_u32 vcc, s10, v105
  ds_add_rtn_u32 v20, v105, v2 offset:0
  v_cmpx_gt_u32 vcc, s10, v106
  ds_add_rtn_u32 v21, v106, v2 offset:0
K_RK4:
  s_mov_b64 exec, -1
  s_waitcnt vmcnt(2)
K_C5:
  v_cmp_ne_u32_sdwa vcc, v87, v42 src0_sel:WORD_1 src1_sel:WORD_1
  v_lshlrev_b32_sdwa v108, 4, v87 dst_sel:DWORD dst_unused:UNUSED_PAD src0_sel:DWORD src1_sel:BYTE_0
  v_lshlrev_b32_sdwa v109, 4, v87 dst_sel:DWORD dst_unused:UNUSED_PAD src0_sel:DWORD src1_sel:BYTE_1
  v_and_or_b32 v108, v84, 12, v108
  v_and_or_b32 v109, v85, 12, v109
  s_cbranch_vccnz K_S5
K_D5:
  v_cmpx_gt_u32 vcc, s10, v108
  ds_add_rtn_u32 v23, v108, v2 offset:0
  v_cmpx_gt_u32 vcc, s10, v109
  ds_add_rtn_u32 v24, v109, v2 offset:0
K_RK5:
  s_mov_b64 exec, -1
  s_waitcnt vmcnt(1)
K_C6:
  v_cmp_ne_u32_sdwa vcc, v91, v42 src0_sel:WORD_1 src1_sel:WORD_1
  v_lshlrev_b32_sdwa v111, 4, v91 dst_sel:DWORD dst_unused:UNUSED_PAD src0_sel:DWORD src1_sel:BYTE_0
  v_lshlrev_b32_sdwa v120, 4, v91 dst_sel:DWORD dst_unused:UNUSED_PAD src0_sel:DWORD src1_sel:BYTE_1
  v_and_or_b32 v111, v88, 12, v111
  v_and_or_b32 v120, v89, 12, v120
  s_cbranch_vccnz K_S6
K_D6:
  v_cmpx_gt_u32 vcc, s10, v111
  ds_add_rtn_u32 v26, v111, v2 offset:0
  v_cmpx_gt_u32 vcc, s10, v120
  ds_add_rtn_u32 v27, v120, v2 offset:0
K_RK6:
  s_mov_b64 exec, -1
  s_waitcnt vmcnt(0)
K_C7:
  v_cmp_ne_u32_sdwa vcc, v95, v42 src0_sel:WORD_1 src1_sel:WORD_1
  v_lshlrev_b32_sdwa v122, 4, v95 dst_sel:DWORD dst_unused:UNUSED_PAD src0_sel:DWORD src1_sel:BYTE_0
  v_lshlrev_b32_sdwa v123, 4, v95 dst_sel:DWORD dst_unused:UNUSED_PAD src0_sel:DWORD src1_sel:BYTE_1
  v_and_or_b32 v122, v92, 12, v122
  v_and_or_b32 v123, v93, 12, v123
  s_cbranch_vccnz K_S7
K_D7:
  v_cmpx_gt_u32 vcc, s10, v122
  ds_add_rtn_u32 v29, v122, v2 offset:0
  v_cmpx_gt_u32 vcc, s10, v123
  ds_add_rtn_u32 v30, v123, v2 offset:0
K_RK7:
  s_mov_b64 exec, -1
  s_cmp_eq_u64 s[56:57], 0
  s_cbranch_scc1 K_RK8
  s_waitcnt vmcnt(0)
K_C8:
  v_cmp_ne_u32_sdwa vcc, v99, v42 src0_sel:BYTE_3 src1_sel:BYTE_3
  v_lshlrev_b32_sdwa v125, 4, v99 dst_sel:DWORD dst_unused:UNUSED_PAD src0_sel:DWORD src1_sel:BYTE_0
  v_lshlrev_b32_sdwa v126, 4, v99 dst_sel:DWORD dst_unused:UNUSED_PAD src0_sel:DWORD src1_sel:BYTE_1
  v_lshlrev_b32_sdwa v127, 4, v99 dst_sel:DWORD dst_unused:UNUSED_PAD src0_sel:DWORD src1_sel:BYTE_2
  v_and_or_b32 v125, v96, 12, v125
  v_and_or_b32 v126, v97, 12, v126
  v_and_or_b32 v127, v98, 12, v127
  s_cbranch_vccnz K_RT8
K_D8:
  v_cmpx_gt_u32 vcc, s10, v125
  ds_add_rtn_u32 v32, v125, v2 offset:0
  v_cmpx_gt_u32 vcc, s10, v126
  ds_add_rtn_u32 v33, v126, v2 offset:0
  v_cmpx_gt_u32 vcc, s10, v127
  s_cbranch_execz K_RK8
  ds_add_rtn_u32 v34, v127, v2 offset:0
  s_or_b32 s8, exec_lo, exec_hi
  s_and_b32 s8, s8, 0x88888888
  s_or_b32 s82, s82, s8
K_RK8:
  s_mov_b64 exec, -1
  s_mov_b64 exec, 1
  ds_add_u32 v3, v2 offset:16184
  s_mov_b64 exec, -1
  s_mov_b32 s80, 0x400000
K_PFW:
  ds_read_b32 v4, v3 offset:16180
  s_waitcnt lgkmcnt(0)
  v_readfirstlane_b32 s8, v4
  s_cmp_lg_u32 s8, 0
  s_cbranch_scc1 K_PFW_D
  s_sub_u32 s80, s80, 1
  s_cbranch_scc0 K_PFW
K_PFW_D:
  s_cmp_gt_u32 s8, 728
  s_cselect_b64 s[82:83], -1, s[82:83]
  s_cbranch_scc1 K_SW8
  ds_read_b32 v35, v35 offset:0
  ds_read_b32 v36, v36 offset:0
  ds_read_b32 v38, v38 offset:0
  ds_read_b32 v39, v39 offset:0
  ds_read_b32 v41, v41 offset:0
  ds_read_b32 v100, v100 offset:0
  ds_read_b32 v102, v102 offset:0
  s_waitcnt lgkmcnt(5)
  v_lshl_add_u32 v35, v8, 4, v35
  ds_read_b32 v103, v103 offset:0
  ds_write_b32 v35, v64
  v_lshl_add_u32 v36, v9, 4, v36
  ds_read_b32 v105, v105 offset:0
  ds_write_b32 v36, v65
  s_waitcnt lgkmcnt(7)
  v_lshl_add_u32 v38, v11, 4, v38
  ds_read_b32 v106, v106 offset:0
  ds_write_b32 v38, v68
  v_lshl_add_u32 v39, v12, 4, v39
  ds_read_b32 v108, v108 offset:0
  ds_write_b32 v39, v69
  s_waitcnt lgkmcnt(9)
  v_lshl_add_u32 v41, v14, 4, v41
  ds_read_b32 v109, v109 offset:0
  ds_write_b32 v41, v72
  v_lshl_add_u32 v100, v15, 4, v100
  ds_read_b32 v111, v111 offset:0
  ds_write_b32 v100, v73
  s_waitcnt lgkmcnt(11)
  v_lshl_add_u32 v102, v17, 4, v102
  ds_read_b32 v120, v120 offset:0
  ds_write_b32 v102, v76
  v_lshl_add_u32 v103, v18, 4, v103
  ds_read_b32 v122, v122 offset:0
  ds_write_b32 v103, v77
  s_waitcnt lgkmcnt(11)
  v_lshl_add_u32 v105, v20, 4, v105
  ds_read_b32 v123, v123 offset:0
  ds_write_b32 v105, v80
  v_lshl_add_u32 v106, v21, 4, v106
  ds_read_b32 v47, v47 offset:0
  ds_write_b32 v106, v81
  s_waitcnt lgkmcnt(11)
  v_lshl_add_u32 v108, v23, 4, v108
  ds_write_b32 v108, v84
  v_lshl_add_u32 v109, v24, 4, v109
  ds_write_b32 v109, v85
  s_waitcnt lgkmcnt(9)
  v_lshl_add_u32 v111, v26, 4, v111
  ds_write_b32 v111, v88
  v_lshl_add_u32 v120, v27, 4, v120
  ds_write_b32 v120, v89
  s_waitcnt lgkmcnt(7)
  v_lshl_add_u32 v122, v29, 4, v122
  ds_write_b32 v122, v92
  v_lshl_add_u32 v123, v30, 4, v123
  ds_write_b32 v123, v93
  s_waitcnt lgkmcnt(7)
  v_lshl_add_u32 v47, v48, 4, v47
  ds_write_b32 v47, v46
  s_or_b32 s8, s56, s57
  s_or_b32 s8, s8, s15
  s_cbranch_scc1 K_SX
K_SW8:
  s_cmp_eq_u64 s[82:83], 0
  s_cselect_b32 s8, 1, 0x10001
  v_mov_b32 v2, s8
  s_mov_b64 exec, 1
  ds_add_u32 v3, v2 offset:16224
  s_mov_b64 exec, -1
  s_setprio 1
  v_mov_b32 v4, s81
  s_mov_b32 s9, 13959168
  s_or_b32 s8, s2, s3
  s_cbranch_scc1 K_PAR
  s_mov_b64 exec, 1
  buffer_store_dword v4, v3, s[52:55], s9 offen sc1
  s_mov_b64 exec, -1
  s_branch K_PAR
K_GM:
  v_lshrrev_b32 v2, 4, v1
  v_bfe_u32 v6, v1, 2, 2
  v_lshl_add_u32 v4, v2, 3, v6
  v_lshrrev_b32 v5, 1, v6
  v_and_b32 v6, 1, v2
  v_lshl_or_b32 v5, v6, 1, v5
  v_xor_b32 v5, s7, v5
  v_lshlrev_b32 v5, 5, v5
  v_lshl_add_u32 v4, v4, 7, v5
  v_and_b32 v5, 3, v1
  v_lshl_add_u32 v4, v5, 3, v4
  v_add_u32 v58, 98304, v4
  v_lshrrev_b32 v2, 4, v1
  v_and_b32 v5, 15, v1
  v_xor_b32 v4, v2, v5
  v_lshlrev_b32 v6, 9, v5
  v_add_u32 v6, 16384, v6
  v_lshl_add_u32 v60, v4, 4, v6
  v_xor_b32 v61, 64, v60
  v_xor_b32 v62, 0x80, v60
  v_xor_b32 v63, 0xc0, v60
  s_cmp_gt_u32 s3, 8
  s_cbranch_scc1 K_G2
  s_setprio 2
  v_mov_b32 v2, v60
  v_mov_b32 v20, 1
  v_and_b32 v1, 1, v1
  v_lshlrev_b32 v1, 15, v1
  v_xor_b32 v1, 0x8000, v1
  s_mov_b32 s12, s4
  s_mul_i32 s14, s12, 2686976
  s_lshr_b32 s8, s6, 1
  s_add_u32 s14, s14, s8
  s_lshl_b32 s12, s12, 13
  s_lshl_b32 s9, s5, 7
  s_add_u32 s12, s12, s9
  s_add_u32 s12, s12, 13926400
  s_waitcnt vmcnt(0)
  s_mov_b32 s80, 0x400000
K_GW1:
  ds_read_b32 v0, v3 offset:16160
  s_waitcnt lgkmcnt(0)
  v_readfirstlane_b32 s8, v0
  s_cmp_ge_i32 s8, 11
  s_cbranch_scc1 K_GW1_D
  s_sleep 1
  s_sub_u32 s80, s80, 1
  s_cbranch_scc0 K_GW1
K_GW1_D:
  ds_read_b64_tr_b16 v[64:65], v58 offset:0
  ds_read_b64_tr_b16 v[66:67], v58 offset:512
  ds_read_b64_tr_b16 v[96:97], v58 offset:32768
  ds_read_b64_tr_b16 v[98:99], v58 offset:33280
  ds_read_b128 v[24:27], v2 offset:0
  v_xor_b32 v2, 64, v2
  ds_read_b64_tr_b16 v[68:69], v58 offset:4096
  ds_read_b64_tr_b16 v[70:71], v58 offset:4608
  ds_read_b64_tr_b16 v[100:101], v58 offset:36864
  ds_read_b64_tr_b16 v[102:103], v58 offset:37376
  ds_read_b128 v[28:31], v2 offset:0
  v_xor_b32 v2, 192, v2
  ds_read_b64_tr_b16 v[72:73], v58 offset:8192
  ds_read_b64_tr_b16 v[74:75], v58 offset:8704
  ds_read_b64_tr_b16 v[104:105], v58 offset:40960
  ds_read_b64_tr_b16 v[106:107], v58 offset:41472
  ds_read_b128 v[32:35], v2 offset:0
  v_xor_b32 v2, 64, v2
  s_waitcnt lgkmcnt(10)
  v_mfma_f32_16x16x32_bf16 v[4:7], v[24:27], v[64:67], 0
  v_mfma_f32_16x16x32_bf16 v[60:63], v[24:27], v[96:99], 0
  ds_read_b64_tr_b16 v[76:77], v58 offset:12288
  ds_read_b64_tr_b16 v[78:79], v58 offset:12800
  ds_read_b64_tr_b16 v[108:109], v58 offset:45056
  ds_read_b64_tr_b16 v[110:111], v58 offset:45568
  ds_read_b128 v[36:39], v2 offset:0
  v_xor_b32 v2, 192, v2
  s_waitcnt lgkmcnt(10)
  v_mfma_f32_16x16x32_bf16 v[4:7], v[28:31], v[68:71], v[4:7]
  v_mfma_f32_16x16x32_bf16 v[60:63], v[28:31], v[100:103], v[60:63]
  ds_read_b64_tr_b16 v[80:81], v58 offset:16384
  ds_read_b64_tr_b16 v[82:83], v58 offset:16896
  ds_read_b64_tr_b16 v[112:113], v58 offset:49152
  ds_read_b64_tr_b16 v[114:115], v58 offset:49664
  ds_read_b128 v[24:27], v2 offset:256
  v_xor_b32 v2, 64, v2
  s_waitcnt lgkmcnt(10)
  v_mfma_f32_16x16x32_bf16 v[4:7], v[32:35], v[72:75], v[4:7]
  v_mfma_f32_16x16x32_bf16 v[60:63], v[32:35], v[104:107], v[60:63]
  ds_read_b64_tr_b16 v[84:85], v58 offset:20480
  ds_read_b64_tr_b16 v[86:87], v58 offset:20992
  ds_read_b64_tr_b16 v[116:117], v58 offset:53248
  ds_read_b64_tr_b16 v[118:119], v58 offset:53760
  ds_read_b128 v[28:31], v2 offset:256
  v_xor_b32 v2, 192, v2
  s_waitcnt lgkmcnt(10)
  v_mfma_f32_16x16x32_bf16 v[4:7], v[36:39], v[76:79], v[4:7]
  v_mfma_f32_16x16x32_bf16 v[60:63], v[36:39], v[108:111], v[60:63]
  ds_read_b64_tr_b16 v[88:89], v58 offset:24576
  ds_read_b64_tr_b16 v[90:91], v58 offset:25088
  ds_read_b64_tr_b16 v[120:121], v58 offset:57344
  ds_read_b64_tr_b16 v[122:123], v58 offset:57856
  ds_read_b128 v[32:35], v2 offset:256
  v_xor_b32 v2, 64, v2
  s_waitcnt lgkmcnt(10)
  v_mfma_f32_16x16x32_bf16 v[4:7], v[24:27], v[80:83], v[4:7]
  v_mfma_f32_16x16x32_bf16 v[60:63], v[24:27], v[112:115], v[60:63]
  ds_read_b64_tr_b16 v[92:93], v58 offset:28672
  ds_read_b64_tr_b16 v[94:95], v58 offset:29184
  ds_read_b64_tr_b16 v[124:125], v58 offset:61440
  ds_read_b64_tr_b16 v[126:127], v58 offset:61952
  ds_read_b128 v[36:39], v2 offset:256
  v_xor_b32 v2, 192, v2
  s_mov_b64 exec, 1
  ds_add_u32 v3, v20 offset:16164
  s_mov_b64 exec, -1
  s_waitcnt lgkmcnt(11)
  v_mfma_f32_16x16x32_bf16 v[4:7], v[28:31], v[84:87], v[4:7]
  v_mfma_f32_16x16x32_bf16 v[60:63], v[28:31], v[116:119], v[60:63]
  ds_read_b128 v[24:27], v2 offset:8192
  v_xor_b32 v2, 64, v2
  ds_read_b128 v[28:31], v2 offset:8192
  v_xor_b32 v2, 192, v2
  s_waitcnt lgkmcnt(8)
  v_mfma_f32_16x16x32_bf16 v[4:7], v[32:35], v[88:91], v[4:7]
  v_mfma_f32_16x16x32_bf16 v[60:63], v[32:35], v[120:123], v[60:63]
  ds_read_b128 v[32:35], v2 offset:8192
  v_xor_b32 v2, 64, v2
  s_waitcnt lgkmcnt(4)
  v_mfma_f32_16x16x32_bf16 v[4:7], v[36:39], v[92:95], v[4:7]
  v_mfma_f32_16x16x32_bf16 v[60:63], v[36:39], v[124:127], v[60:63]
  ds_read_b128 v[36:39], v2 offset:8192
  v_xor_b32 v2, 192, v2
  s_waitcnt lgkmcnt(2)
  v_mfma_f32_16x16x32_bf16 v[8:11], v[24:27], v[64:67], 0
  v_mfma_f32_16x16x32_bf16 v[56:59], v[24:27], v[96:99], 0
  ds_read_b128 v[24:27], v2 offset:8448
  v_xor_b32 v2, 64, v2
  v_mfma_f32_16x16x32_bf16 v[8:11], v[28:31], v[68:71], v[8:11]
  v_mfma_f32_16x16x32_bf16 v[56:59], v[28:31], v[100:103], v[56:59]
  ds_read_b128 v[28:31], v2 offset:8448
  v_xor_b32 v2, 192, v2
  v_fma_f32 v4, s72, v4, -0.5
  v_fma_f32 v5, s72, v5, -0.5
  s_waitcnt lgkmcnt(2)
  v_mfma_f32_16x16x32_bf16 v[8:11], v[32:35], v[72:75], v[8:11]
  v_fma_f32 v6, s72, v6, -0.5
  v_fma_f32 v7, s72, v7, -0.5
  v_mfma_f32_16x16x32_bf16 v[56:59], v[32:35], v[104:107], v[56:59]
  ds_read_b128 v[32:35], v2 offset:8448
  v_xor_b32 v2, 64, v2
  v_mul_f32 v60, s74, v60
  v_mfma_f32_16x16x32_bf16 v[8:11], v[36:39], v[76:79], v[8:11]
  v_mul_f32 v61, s74, v61
  v_mul_f32 v62, s74, v62
  v_mfma_f32_16x16x32_bf16 v[56:59], v[36:39], v[108:111], v[56:59]
  ds_read_b128 v[36:39], v2 offset:8448
  v_xor_b32 v2, 192, v2
  v_mul_f32 v63, s74, v63
  s_waitcnt lgkmcnt(2)
  v_mfma_f32_16x16x32_bf16 v[8:11], v[24:27], v[80:83], v[8:11]
  v_add_u32 v60, v1, v60
  v_add_u32 v61, v1, v61
  v_mfma_f32_16x16x32_bf16 v[56:59], v[24:27], v[112:115], v[56:59]
  ds_read_b128 v[24:27], v2 offset:16384
  v_xor_b32 v2, 64, v2
  v_mfma_f32_16x16x32_bf16 v[8:11], v[28:31], v[84:87], v[8:11]
  v_add_u32 v62, v1, v62
  v_add_u32 v63, v1, v63
  v_mfma_f32_16x16x32_bf16 v[56:59], v[28:31], v[116:119], v[56:59]
  ds_read_b128 v[28:31], v2 offset:16384
  v_xor_b32 v2, 192, v2
  s_waitcnt lgkmcnt(2)
  v_mfma_f32_16x16x32_bf16 v[8:11], v[32:35], v[88:91], v[8:11]
  v_perm_b32 v4, v4, v60, s79
  v_perm_b32 v5, v5, v61, s79
  v_mfma_f32_16x16x32_bf16 v[56:59], v[32:35], v[120:123], v[56:59]
  ds_read_b128 v[32:35], v2 offset:16384
  v_xor_b32 v2, 64, v2
  v_mfma_f32_16x16x32_bf16 v[8:11], v[36:39], v[92:95], v[8:11]
  v_perm_b32 v6, v6, v62, s79
  v_perm_b32 v7, v7, v63, s79
  v_mfma_f32_16x16x32_bf16 v[56:59], v[36:39], v[124:127], v[56:59]
  ds_read_b128 v[36:39], v2 offset:16384
  v_xor_b32 v2, 192, v2
  s_waitcnt lgkmcnt(2)
  v_mfma_f32_16x16x32_bf16 v[12:15], v[24:27], v[64:67], 0
  v_mfma_f32_16x16x32_bf16 v[60:63], v[24:27], v[96:99], 0
  ds_read_b128 v[24:27], v2 offset:16640
  v_xor_b32 v2, 64, v2
  v_mfma_f32_16x16x32_bf16 v[12:15], v[28:31], v[68:71], v[12:15]
  v_mfma_f32_16x16x32_bf16 v[60:63], v[28:31], v[100:103], v[60:63]
  ds_read_b128 v[28:31], v2 offset:16640
  v_xor_b32 v2, 192, v2
  v_fma_f32 v8, s72, v8, -0.5
  v_fma_f32 v9, s72, v9, -0.5
  s_waitcnt lgkmcnt(2)
  v_mfma_f32_16x16x32_bf16 v[12:15], v[32:35], v[72:75], v[12:15]
  v_fma_f32 v10, s72, v10, -0.5
  v_fma_f32 v11, s72, v11, -0.5
  v_mfma_f32_16x16x32_bf16 v[60:63], v[32:35], v[104:107], v[60:63]
  ds_read_b128 v[32:35], v2 offset:16640
  v_xor_b32 v2, 64, v2
  v_mul_f32 v56, s74, v56
  v_mfma_f32_16x16x32_bf16 v[12:15], v[36:39], v[76:79], v[12:15]
  v_mul_f32 v57, s74, v57
  v_mul_f32 v58, s74, v58
  v_mfma_f32_16x16x32_bf16 v[60:63], v[36:39], v[108:111], v[60:63]
  ds_read_b128 v[36:39], v2 offset:16640
  v_xor_b32 v2, 192, v2
  v_mul_f32 v59, s74, v59
  s_waitcnt lgkmcnt(2)
  v_mfma_f32_16x16x32_bf16 v[12:15], v[24:27], v[80:83], v[12:15]
  v_add_u32 v56, v1, v56
  v_add_u32 v57, v1, v57
  v_mfma_f32_16x16x32_bf16 v[60:63], v[24:27], v[112:115], v[60:63]
  ds_read_b32 v0, v3 offset:16160
  ds_read_b128 v[24:27], v2 offset:24576
  v_xor_b32 v2, 64, v2
  v_mfma_f32_16x16x32_bf16 v[12:15], v[28:31], v[84:87], v[12:15]
  v_add_u32 v58, v1, v58
  v_add_u32 v59, v1, v59
  v_mfma_f32_16x16x32_bf16 v[60:63], v[28:31], v[116:119], v[60:63]
  ds_read_b128 v[28:31], v2 offset:24576
  v_xor_b32 v2, 192, v2
  s_waitcnt lgkmcnt(3)
  v_mfma_f32_16x16x32_bf16 v[12:15], v[32:35], v[88:91], v[12:15]
  v_perm_b32 v8, v8, v56, s79
  v_perm_b32 v9, v9, v57, s79
  v_mfma_f32_16x16x32_bf16 v[60:63], v[32:35], v[120:123], v[60:63]
  ds_read_b128 v[32:35], v2 offset:24576
  v_xor_b32 v2, 64, v2
  v_mfma_f32_16x16x32_bf16 v[12:15], v[36:39], v[92:95], v[12:15]
  v_perm_b32 v10, v10, v58, s79
  v_perm_b32 v11, v11, v59, s79
  v_mfma_f32_16x16x32_bf16 v[60:63], v[36:39], v[124:127], v[60:63]
  ds_read_b128 v[36:39], v2 offset:24576
  v_xor_b32 v2, 192, v2
  s_waitcnt lgkmcnt(4)
  v_readfirstlane_b32 s8, v0
  s_cmp_lt_i32 s8, 12
  s_cbranch_scc1 K_XW13
K_XK13:
  s_waitcnt lgkmcnt(2)
  v_mfma_f32_16x16x32_bf16 v[16:19], v[24:27], v[64:67], 0
  v_mfma_f32_16x16x32_bf16 v[56:59], v[24:27], v[96:99], 0
  ds_read_b128 v[24:27], v2 offset:24832
  v_xor_b32 v2, 64, v2
  v_mfma_f32_16x16x32_bf16 v[16:19], v[28:31], v[68:71], v[16:19]
  v_mfma_f32_16x16x32_bf16 v[56:59], v[28:31], v[100:103], v[56:59]
  ds_read_b128 v[28:31], v2 offset:24832
  v_xor_b32 v2, 192, v2
  v_fma_f32 v12, s72, v12, -0.5
  v_fma_f32 v13, s72, v13, -0.5
  s_waitcnt lgkmcnt(2)
  v_mfma_f32_16x16x32_bf16 v[16:19], v[32:35], v[72:75], v[16:19]
  v_fma_f32 v14, s72, v14, -0.5
  v_fma_f32 v15, s72, v15, -0.5
  v_mfma_f32_16x16x32_bf16 v[56:59], v[32:35], v[104:107], v[56:59]
  ds_read_b128 v[32:35], v2 offset:24832
  v_xor_b32 v2, 64, v2
  v_mul_f32 v60, s74, v60
  v_mfma_f32_16x16x32_bf16 v[16:19], v[36:39], v[76:79], v[16:19]
  v_mul_f32 v61, s74, v61
  v_mul_f32 v62, s74, v62
  v_mfma_f32_16x16x32_bf16 v[56:59], v[36:39], v[108:111], v[56:59]
  ds_read_b128 v[36:39], v2 offset:24832
  v_xor_b32 v2, 192, v2
  v_mul_f32 v63, s74, v63
  s_waitcnt lgkmcnt(2)
  v_mfma_f32_16x16x32_bf16 v[16:19], v[24:27], v[80:83], v[16:19]
  v_add_u32 v60, v1, v60
  v_add_u32 v61, v1, v61
  v_mfma_f32_16x16x32_bf16 v[56:59], v[24:27], v[112:115], v[56:59]
  ds_read_b32 v0, v3 offset:16160
  ds_read_b128 v[24:27], v2 offset:32768
  v_xor_b32 v2, 64, v2
  v_mfma_f32_16x16x32_bf16 v[16:19], v[28:31], v[84:87], v[16:19]
  v_add_u32 v62, v1, v62
  v_add_u32 v63, v1, v63
  v_mfma_f32_16x16x32_bf16 v[56:59], v[28:31], v[116:119], v[56:59]
  ds_read_b128 v[28:31], v2 offset:32768
  v_xor_b32 v2, 192, v2
  s_waitcnt lgkmcnt(3)
  v_mfma_f32_16x16x32_bf16 v[16:19], v[32:35], v[88:91], v[16:19]
  v_perm_b32 v12, v12, v60, s79
  v_perm_b32 v13, v13, v61, s79
  v_mfma_f32_16x16x32_bf16 v[56:59], v[32:35], v[120:123], v[56:59]
  ds_read_b128 v[32:35], v2 offset:32768
  v_xor_b32 v2, 64, v2
  v_mfma_f32_16x16x32_bf16 v[16:19], v[36:39], v[92:95], v[16:19]
  v_perm_b32 v14, v14, v62, s79
  v_perm_b32 v15, v15, v63, s79
  v_mfma_f32_16x16x32_bf16 v[56:59], v[36:39], v[124:127], v[56:59]
  ds_read_b128 v[36:39], v2 offset:32768
  v_xor_b32 v2, 192, v2
  s_waitcnt lgkmcnt(4)
  v_readfirstlane_b32 s8, v0
  s_cmp_lt_i32 s8, 13
  s_cbranch_scc1 K_XW14
K_XK14:
  s_waitcnt lgkmcnt(2)
  v_mfma_f32_16x16x32_bf16 v[20:23], v[24:27], v[64:67], 0
  v_mfma_f32_16x16x32_bf16 v[60:63], v[24:27], v[96:99], 0
  ds_read_b128 v[24:27], v2 offset:33024
  v_xor_b32 v2, 64, v2
  v_mfma_f32_16x16x32_bf16 v[20:23], v[28:31], v[68:71], v[20:23]
  v_mfma_f32_16x16x32_bf16 v[60:63], v[28:31], v[100:103], v[60:63]
  ds_read_b128 v[28:31], v2 offset:33024
  v_xor_b32 v2, 192, v2
  v_fma_f32 v16, s72, v16, -0.5
  v_fma_f32 v17, s72, v17, -0.5
  s_waitcnt lgkmcnt(2)
  v_mfma_f32_16x16x32_bf16 v[20:23], v[32:35], v[72:75], v[20:23]
  v_fma_f32 v18, s72, v18, -0.5
  v_fma_f32 v19, s72, v19, -0.5
  v_mfma_f32_16x16x32_bf16 v[60:63], v[32:35], v[104:107], v[60:63]
  ds_read_b128 v[32:35], v2 offset:33024
  v_xor_b32 v2, 64, v2
  v_mul_f32 v56, s74, v56
  v_mfma_f32_16x16x32_bf16 v[20:23], v[36:39], v[76:79], v[20:23]
  v_mul_f32 v57, s74, v57
  v_mul_f32 v58, s74, v58
  v_mfma_f32_16x16x32_bf16 v[60:63], v[36:39], v[108:111], v[60:63]
  ds_read_b128 v[36:39], v2 offset:33024
  v_xor_b32 v2, 192, v2
  v_mul_f32 v59, s74, v59
  s_waitcnt lgkmcnt(2)
  v_mfma_f32_16x16x32_bf16 v[20:23], v[24:27], v[80:83], v[20:23]
  v_add_u32 v56, v1, v56
  v_add_u32 v57, v1, v57
  v_mfma_f32_16x16x32_bf16 v[60:63], v[24:27], v[112:115], v[60:63]
  ds_read_b32 v0, v3 offset:16160
  ds_read_b128 v[24:27], v2 offset:40960
  v_xor_b32 v2, 64, v2
  v_mfma_f32_16x16x32_bf16 v[20:23], v[28:31], v[84:87], v[20:23]
  v_add_u32 v58, v1, v58
  v_add_u32 v59, v1, v59
  v_mfma_f32_16x16x32_bf16 v[60:63], v[28:31], v[116:119], v[60:63]
  ds_read_b128 v[28:31], v2 offset:40960
  v_xor_b32 v2, 192, v2
  s_waitcnt lgkmcnt(3)
  v_mfma_f32_16x16x32_bf16 v[20:23], v[32:35], v[88:91], v[20:23]
  v_perm_b32 v16, v16, v56, s79
  v_perm_b32 v17, v17, v57, s79
  v_mfma_f32_16x16x32_bf16 v[60:63], v[32:35], v[120:123], v[60:63]
  ds_read_b128 v[32:35], v2 offset:40960
  v_xor_b32 v2, 64, v2
  v_mfma_f32_16x16x32_bf16 v[20:23], v[36:39], v[92:95], v[20:23]
  v_perm_b32 v18, v18, v58, s79
  v_perm_b32 v19, v19, v59, s79
  v_mfma_f32_16x16x32_bf16 v[60:63], v[36:39], v[124:127], v[60:63]
  ds_read_b128 v[36:39], v2 offset:40960
  v_xor_b32 v2, 192, v2
  s_waitcnt lgkmcnt(4)
  v_readfirstlane_b32 s8, v0
  s_cmp_lt_i32 s8, 14
  s_cbranch_scc1 K_XW15
K_XK15:
  s_waitcnt lgkmcnt(2)
  v_mfma_f32_16x16x32_bf16 v[40:43], v[24:27], v[64:67], 0
  v_mfma_f32_16x16x32_bf16 v[56:59], v[24:27], v[96:99], 0
  ds_read_b128 v[24:27], v2 offset:41216
  v_xor_b32 v2, 64, v2
  v_mfma_f32_16x16x32_bf16 v[40:43], v[28:31], v[68:71], v[40:43]
  v_mfma_f32_16x16x32_bf16 v[56:59], v[28:31], v[100:103], v[56:59]
  ds_read_b128 v[28:31], v2 offset:41216
  v_xor_b32 v2, 192, v2
  v_fma_f32 v20, s72, v20, -0.5
  v_fma_f32 v21, s72, v21, -0.5
  s_waitcnt lgkmcnt(2)
  v_mfma_f32_16x16x32_bf16 v[40:43], v[32:35], v[72:75], v[40:43]
  v_fma_f32 v22, s72, v22, -0.5
  v_fma_f32 v23, s72, v23, -0.5
  v_mfma_f32_16x16x32_bf16 v[56:59], v[32:35], v[104:107], v[56:59]
  ds_read_b128 v[32:35], v2 offset:41216
  v_xor_b32 v2, 64, v2
  v_mul_f32 v60, s74, v60
  v_mfma_f32_16x16x32_bf16 v[40:43], v[36:39], v[76:79], v[40:43]
  v_mul_f32 v61, s74, v61
  v_mul_f32 v62, s74, v62
  v_mfma_f32_16x16x32_bf16 v[56:59], v[36:39], v[108:111], v[56:59]
  ds_read_b128 v[36:39], v2 offset:41216
  v_xor_b32 v2, 192, v2
  v_mul_f32 v63, s74, v63
  s_waitcnt lgkmcnt(2)
  v_mfma_f32_16x16x32_bf16 v[40:43], v[24:27], v[80:83], v[40:43]
  v_add_u32 v60, v1, v60
  v_add_u32 v61, v1, v61
  v_mfma_f32_16x16x32_bf16 v[56:59], v[24:27], v[112:115], v[56:59]
  ds_read_b32 v0, v3 offset:16160
  ds_read_b128 v[24:27], v2 offset:49152
  v_xor_b32 v2, 64, v2
  v_mfma_f32_16x16x32_bf16 v[40:43], v[28:31], v[84:87], v[40:43]
  v_add_u32 v62, v1, v62
  v_add_u32 v63, v1, v63
  v_mfma_f32_16x16x32_bf16 v[56:59], v[28:31], v[116:119], v[56:59]
  ds_read_b128 v[28:31], v2 offset:49152
  v_xor_b32 v2, 192, v2
  s_waitcnt lgkmcnt(3)
  v_mfma_f32_16x16x32_bf16 v[40:43], v[32:35], v[88:91], v[40:43]
  v_perm_b32 v20, v20, v60, s79
  v_perm_b32 v21, v21, v61, s79
  v_mfma_f32_16x16x32_bf16 v[56:59], v[32:35], v[120:123], v[56:59]
  ds_read_b128 v[32:35], v2 offset:49152
  v_xor_b32 v2, 64, v2
  v_mfma_f32_16x16x32_bf16 v[40:43], v[36:39], v[92:95], v[40:43]
  v_perm_b32 v22, v22, v62, s79
  v_perm_b32 v23, v23, v63, s79
  v_mfma_f32_16x16x32_bf16 v[56:59], v[36:39], v[124:127], v[56:59]
  ds_read_b128 v[36:39], v2 offset:49152
  v_xor_b32 v2, 192, v2
  s_waitcnt lgkmcnt(4)
  v_readfirstlane_b32 s8, v0
  s_cmp_lt_i32 s8, 15
  s_cbranch_scc1 K_XW16
K_XK16:
  s_waitcnt lgkmcnt(2)
  v_mfma_f32_16x16x32_bf16 v[44:47], v[24:27], v[64:67], 0
  v_mfma_f32_16x16x32_bf16 v[60:63], v[24:27], v[96:99], 0
  ds_read_b128 v[24:27], v2 offset:49408
  v_xor_b32 v2, 64, v2
  v_mfma_f32_16x16x32_bf16 v[44:47], v[28:31], v[68:71], v[44:47]
  v_mfma_f32_16x16x32_bf16 v[60:63], v[28:31], v[100:103], v[60:63]
  ds_read_b128 v[28:31], v2 offset:49408
  v_xor_b32 v2, 192, v2
  v_fma_f32 v40, s72, v40, -0.5
  v_fma_f32 v41, s72, v41, -0.5
  s_waitcnt lgkmcnt(2)
  v_mfma_f32_16x16x32_bf16 v[44:47], v[32:35], v[72:75], v[44:47]
  v_fma_f32 v42, s72, v42, -0.5
  v_fma_f32 v43, s72, v43, -0.5
  v_mfma_f32_16x16x32_bf16 v[60:63], v[32:35], v[104:107], v[60:63]
  ds_read_b128 v[32:35], v2 offset:49408
  v_xor_b32 v2, 64, v2
  v_mul_f32 v56, s74, v56
  v_mfma_f32_16x16x32_bf16 v[44:47], v[36:39], v[76:79], v[44:47]
  v_mul_f32 v57, s74, v57
  v_mul_f32 v58, s74, v58
  v_mfma_f32_16x16x32_bf16 v[60:63], v[36:39], v[108:111], v[60:63]
  ds_read_b128 v[36:39], v2 offset:49408
  v_xor_b32 v2, 192, v2
  v_mul_f32 v59, s74, v59
  s_waitcnt lgkmcnt(2)
  v_mfma_f32_16x16x32_bf16 v[44:47], v[24:27], v[80:83], v[44:47]
  v_add_u32 v56, v1, v56
  v_add_u32 v57, v1, v57
  v_mfma_f32_16x16x32_bf16 v[60:63], v[24:27], v[112:115], v[60:63]
  ds_read_b32 v0, v3 offset:16160
  ds_read_b128 v[24:27], v2 offset:57344
  v_xor_b32 v2, 64, v2
  v_mfma_f32_16x16x32_bf16 v[44:47], v[28:31], v[84:87], v[44:47]
  v_add_u32 v58, v1, v58
  v_add_u32 v59, v1, v59
  v_mfma_f32_16x16x32_bf16 v[60:63], v[28:31], v[116:119], v[60:63]
  ds_read_b128 v[28:31], v2 offset:57344
  v_xor_b32 v2, 192, v2
  s_waitcnt lgkmcnt(3)
  v_mfma_f32_16x16x32_bf16 v[44:47], v[32:35], v[88:91], v[44:47]
  v_perm_b32 v40, v40, v56, s79
  v_perm_b32 v41, v41, v57, s79
  v_mfma_f32_16x16x32_bf16 v[60:63], v[32:35], v[120:123], v[60:63]
  ds_read_b128 v[32:35], v2 offset:57344
  v_xor_b32 v2, 64, v2
  v_mfma_f32_16x16x32_bf16 v[44:47], v[36:39], v[92:95], v[44:47]
  v_perm_b32 v42, v42, v58, s79
  v_perm_b32 v43, v43, v59, s79
  v_mfma_f32_16x16x32_bf16 v[60:63], v[36:39], v[124:127], v[60:63]
  ds_read_b128 v[36:39], v2 offset:57344
  v_xor_b32 v2, 192, v2
  s_waitcnt lgkmcnt(4)
  v_readfirstlane_b32 s8, v0
  s_cmp_lt_i32 s8, 16
  s_cbranch_scc1 K_XW17
K_XK17:
  s_waitcnt lgkmcnt(2)
  v_mfma_f32_16x16x32_bf16 v[48:51], v[24:27], v[64:67], 0
  v_mfma_f32_16x16x32_bf16 v[56:59], v[24:27], v[96:99], 0
  ds_read_b128 v[24:27], v2 offset:57600
  v_xor_b32 v2, 64, v2
  v_mfma_f32_16x16x32_bf16 v[48:51], v[28:31], v[68:71], v[48:51]
  v_mfma_f32_16x16x32_bf16 v[56:59], v[28:31], v[100:103], v[56:59]
  ds_read_b128 v[28:31], v2 offset:57600
  v_xor_b32 v2, 192, v2
  v_fma_f32 v44, s72, v44, -0.5
  v_fma_f32 v45, s72, v45, -0.5
  s_waitcnt lgkmcnt(2)
  v_mfma_f32_16x16x32_bf16 v[48:51], v[32:35], v[72:75], v[48:51]
  v_fma_f32 v46, s72, v46, -0.5
  v_fma_f32 v47, s72, v47, -0.5
  v_mfma_f32_16x16x32_bf16 v[56:59], v[32:35], v[104:107], v[56:59]
  ds_read_b128 v[32:35], v2 offset:57600
  v_xor_b32 v2, 64, v2
  v_mul_f32 v60, s74, v60
  v_mfma_f32_16x16x32_bf16 v[48:51], v[36:39], v[76:79], v[48:51]
  v_mul_f32 v61, s74, v61
  v_mul_f32 v62, s74, v62
  v_mfma_f32_16x16x32_bf16 v[56:59], v[36:39], v[108:111], v[56:59]
  ds_read_b128 v[36:39], v2 offset:57600
  v_xor_b32 v2, 192, v2
  v_mul_f32 v63, s74, v63
  s_waitcnt lgkmcnt(2)
  v_mfma_f32_16x16x32_bf16 v[48:51], v[24:27], v[80:83], v[48:51]
  v_add_u32 v60, v1, v60
  v_add_u32 v61, v1, v61
  v_mfma_f32_16x16x32_bf16 v[56:59], v[24:27], v[112:115], v[56:59]
  ds_read_b32 v0, v3 offset:16160
  v_add_u32 v2, 0x10000, v2
  ds_read_b128 v[24:27], v2 offset:0
  v_xor_b32 v2, 64, v2
  v_mfma_f32_16x16x32_bf16 v[48:51], v[28:31], v[84:87], v[48:51]
  v_add_u32 v62, v1, v62
  v_add_u32 v63, v1, v63
  v_mfma_f32_16x16x32_bf16 v[56:59], v[28:31], v[116:119], v[56:59]
  ds_read_b128 v[28:31], v2 offset:0
  v_xor_b32 v2, 192, v2
  s_waitcnt lgkmcnt(3)
  v_mfma_f32_16x16x32_bf16 v[48:51], v[32:35], v[88:91], v[48:51]
  v_perm_b32 v44, v44, v60, s79
  v_perm_b32 v45, v45, v61, s79
  v_mfma_f32_16x16x32_bf16 v[56:59], v[32:35], v[120:123], v[56:59]
  ds_read_b128 v[32:35], v2 offset:0
  v_xor_b32 v2, 64, v2
  v_mfma_f32_16x16x32_bf16 v[48:51], v[36:39], v[92:95], v[48:51]
  v_perm_b32 v46, v46, v62, s79
  v_perm_b32 v47, v47, v63, s79
  v_mfma_f32_16x16x32_bf16 v[56:59], v[36:39], v[124:127], v[56:59]
  ds_read_b128 v[36:39], v2 offset:0
  v_xor_b32 v2, 192, v2
  s_waitcnt lgkmcnt(4)
  v_readfirstlane_b32 s8, v0
  s_cmp_lt_i32 s8, 17
  s_cbranch_scc1 K_XW18
K_XK18:
  s_waitcnt lgkmcnt(2)
  v_mfma_f32_16x16x32_bf16 v[52:55], v[24:27], v[64:67], 0
  v_mfma_f32_16x16x32_bf16 v[60:63], v[24:27], v[96:99], 0
  ds_read_b128 v[24:27], v2 offset:256
  v_xor_b32 v2, 64, v2
  v_mfma_f32_16x16x32_bf16 v[52:55], v[28:31], v[68:71], v[52:55]
  v_mfma_f32_16x16x32_bf16 v[60:63], v[28:31], v[100:103], v[60:63]
  ds_read_b128 v[28:31], v2 offset:256
  v_xor_b32 v2, 192, v2
  v_fma_f32 v48, s72, v48, -0.5
  v_fma_f32 v49, s72, v49, -0.5
  s_waitcnt lgkmcnt(2)
  v_mfma_f32_16x16x32_bf16 v[52:55], v[32:35], v[72:75], v[52:55]
  v_fma_f32 v50, s72, v50, -0.5
  v_fma_f32 v51, s72, v51, -0.5
  v_mfma_f32_16x16x32_bf16 v[60:63], v[32:35], v[104:107], v[60:63]
  ds_read_b128 v[32:35], v2 offset:256
  v_xor_b32 v2, 64, v2
  v_mul_f32 v56, s74, v56
  v_mfma_f32_16x16x32_bf16 v[52:55], v[36:39], v[76:79], v[52:55]
  v_mul_f32 v57, s74, v57
  v_mul_f32 v58, s74, v58
  v_mfma_f32_16x16x32_bf16 v[60:63], v[36:39], v[108:111], v[60:63]
  ds_read_b128 v[36:39], v2 offset:256
  v_xor_b32 v2, 192, v2
  v_mul_f32 v59, s74, v59
  s_waitcnt lgkmcnt(2)
  v_mfma_f32_16x16x32_bf16 v[52:55], v[24:27], v[80:83], v[52:55]
  v_add_u32 v56, v1, v56
  v_add_u32 v57, v1, v57
  v_mfma_f32_16x16x32_bf16 v[60:63], v[24:27], v[112:115], v[60:63]
  ds_read_b32 v0, v3 offset:16160
  ds_read_b128 v[24:27], v2 offset:8192
  v_xor_b32 v2, 64, v2
  v_mfma_f32_16x16x32_bf16 v[52:55], v[28:31], v[84:87], v[52:55]
  v_add_u32 v58, v1, v58
  v_add_u32 v59, v1, v59
  v_mfma_f32_16x16x32_bf16 v[60:63], v[28:31], v[116:119], v[60:63]
  ds_read_b128 v[28:31], v2 offset:8192
  v_xor_b32 v2, 192, v2
  s_waitcnt lgkmcnt(3)
  v_mfma_f32_16x16x32_bf16 v[52:55], v[32:35], v[88:91], v[52:55]
  v_perm_b32 v48, v48, v56, s79
  v_perm_b32 v49, v49, v57, s79
  v_mfma_f32_16x16x32_bf16 v[60:63], v[32:35], v[120:123], v[60:63]
  ds_read_b128 v[32:35], v2 offset:8192
  v_xor_b32 v2, 64, v2
  v_mfma_f32_16x16x32_bf16 v[52:55], v[36:39], v[92:95], v[52:55]
  v_perm_b32 v50, v50, v58, s79
  v_perm_b32 v51, v51, v59, s79
  v_mfma_f32_16x16x32_bf16 v[60:63], v[36:39], v[124:127], v[60:63]
  ds_read_b128 v[36:39], v2 offset:8192
  v_xor_b32 v2, 192, v2
  s_waitcnt lgkmcnt(4)
  v_readfirstlane_b32 s8, v0
  s_cmp_lt_i32 s8, 18
  v_fma_f32 v52, s72, v52, -0.5
  v_fma_f32 v53, s72, v53, -0.5
  v_fma_f32 v54, s72, v54, -0.5
  v_fma_f32 v55, s72, v55, -0.5
  v_mul_f32 v60, s74, v60
  v_mul_f32 v61, s74, v61
  v_mul_f32 v62, s74, v62
  v_mul_f32 v63, s74, v63
  v_add_u32 v60, v1, v60
  v_add_u32 v61, v1, v61
  v_add_u32 v62, v1, v62
  v_add_u32 v63, v1, v63
  v_perm_b32 v52, v52, v60, s79
  v_perm_b32 v53, v53, v61, s79
  v_perm_b32 v54, v54, v62, s79
  v_perm_b32 v55, v55, v63, s79
  s_cbranch_scc1 K_XW19
K_XK19:
  s_waitcnt lgkmcnt(2)
  v_mfma_f32_16x16x32_bf16 v[56:59], v[24:27], v[64:67], 0
  v_mfma_f32_16x16x32_bf16 v[60:63], v[24:27], v[96:99], 0
  ds_read_b128 v[24:27], v2 offset:8448
  v_xor_b32 v2, 64, v2
  v_mfma_f32_16x16x32_bf16 v[56:59], v[28:31], v[68:71], v[56:59]
  v_mfma_f32_16x16x32_bf16 v[60:63], v[28:31], v[100:103], v[60:63]
  ds_read_b128 v[28:31], v2 offset:8448
  v_xor_b32 v2, 192, v2
  s_waitcnt lgkmcnt(2)
  v_mfma_f32_16x16x32_bf16 v[56:59], v[32:35], v[72:75], v[56:59]
  v_mfma_f32_16x16x32_bf16 v[60:63], v[32:35], v[104:107], v[60:63]
  ds_read_b128 v[32:35], v2 offset:8448
  v_xor_b32 v2, 64, v2
  v_mfma_f32_16x16x32_bf16 v[56:59], v[36:39], v[76:79], v[56:59]
  v_mfma_f32_16x16x32_bf16 v[60:63], v[36:39], v[108:111], v[60:63]
  ds_read_b128 v[36:39], v2 offset:8448
  v_xor_b32 v2, 192, v2
  s_waitcnt lgkmcnt(2)
  v_mfma_f32_16x16x32_bf16 v[56:59], v[24:27], v[80:83], v[56:59]
  v_mfma_f32_16x16x32_bf16 v[60:63], v[24:27], v[112:115], v[60:63]
  v_mfma_f32_16x16x32_bf16 v[56:59], v[28:31], v[84:87], v[56:59]
  v_mfma_f32_16x16x32_bf16 v[60:63], v[28:31], v[116:119], v[60:63]
  s_waitcnt lgkmcnt(0)
  v_mfma_f32_16x16x32_bf16 v[56:59], v[32:35], v[88:91], v[56:59]
  v_mfma_f32_16x16x32_bf16 v[60:63], v[32:35], v[120:123], v[60:63]
  v_mfma_f32_16x16x32_bf16 v[56:59], v[36:39], v[92:95], v[56:59]
  v_mfma_f32_16x16x32_bf16 v[60:63], v[36:39], v[124:127], v[60:63]
  v_mov_b32 v0, 0x100
  v_mov_b32 v2, 1
  v_mbcnt_lo_u32_b32 v25, -1, 0
  v_mbcnt_hi_u32_b32 v25, -1, v25
  s_mov_b64 exec, 1
  ds_add_u32 v3, v0 offset:16224
  s_mov_b64 exec, -1
  v_lshrrev_b32 v26, 4, v25
  v_and_b32 v27, 15, v25
  v_lshlrev_b32 v26, 10, v26
  v_lshl_add_u32 v26, v27, 2, v26
  s_lshl_b32 s8, s7, 6
  v_add_u32 v26, s8, v26
  v_fma_f32 v56, s72, v56, -0.5
  v_fma_f32 v57, s72, v57, -0.5
  v_fma_f32 v58, s72, v58, -0.5
  v_fma_f32 v59, s72, v59, -0.5
  v_mul_f32 v60, s74, v60
  v_mul_f32 v61, s74, v61
  v_mul_f32 v62, s74, v62
  v_mul_f32 v63, s74, v63
  v_add_u32 v60, v1, v60
  v_add_u32 v61, v1, v61
  v_add_u32 v62, v1, v62
  v_add_u32 v63, v1, v63
  v_perm_b32 v56, v56, v60, s79
  v_perm_b32 v57, v57, v61, s79
  v_perm_b32 v58, v58, v62, s79
  v_perm_b32 v59, v59, v63, s79
  v_mov_b32 v1, v25
  s_mov_b32 s80, 0x400000
K_TLW:
  ds_read_b32 v0, v3 offset:16200
  s_waitcnt lgkmcnt(0)
  v_readfirstlane_b32 s8, v0
  s_cmp_ge_i32 s8, 8
  s_cbranch_scc1 K_TLW_D
  s_sub_u32 s80, s80, 1
  s_cbranch_scc0 K_TLW
K_TLW_D:
  buffer_store_dword v4, v26, s[52:55], s14 offen offset:0 sc1
  buffer_store_dword v5, v26, s[52:55], s14 offen offset:256 sc1
  buffer_store_dword v6, v26, s[52:55], s14 offen offset:512 sc1
  buffer_store_dword v7, v26, s[52:55], s14 offen offset:768 sc1
  s_add_u32 s14, s14, 4096
  buffer_store_dword v8, v26, s[52:55], s14 offen offset:0 sc1
  buffer_store_dword v9, v26, s[52:55], s14 offen offset:256 sc1
  buffer_store_dword v10, v26, s[52:55], s14 offen offset:512 sc1
  buffer_store_dword v11, v26, s[52:55], s14 offen offset:768 sc1
  s_add_u32 s14, s14, 4096
  buffer_store_dword v12, v26, s[52:55], s14 offen offset:0 sc1
  buffer_store_dword v13, v26, s[52:55], s14 offen offset:256 sc1
  buffer_store_dword v14, v26, s[52:55], s14 offen offset:512 sc1
  buffer_store_dword v15, v26, s[52:55], s14 offen offset:768 sc1
  s_add_u32 s14, s14, 4096
  buffer_store_dword v16, v26, s[52:55], s14 offen offset:0 sc1
  buffer_store_dword v17, v26, s[52:55], s14 offen offset:256 sc1
  buffer_store_dword v18, v26, s[52:55], s14 offen offset:512 sc1
  buffer_store_dword v19, v26, s[52:55], s14 offen offset:768 sc1
  s_add_u32 s14, s14, 4096
  buffer_store_dword v20, v26, s[52:55], s14 offen offset:0 sc1
  buffer_store_dword v21, v26, s[52:55], s14 offen offset:256 sc1
  buffer_store_dword v22, v26, s[52:55], s14 offen offset:512 sc1
  buffer_store_dword v23, v26, s[52:55], s14 offen offset:768 sc1
  s_add_u32 s14, s14, 4096
  buffer_store_dword v40, v26, s[52:55], s14 offen offset:0 sc1
  buffer_store_dword v41, v26, s[52:55], s14 offen offset:256 sc1
  buffer_store_dword v42, v26, s[52:55], s14 offen offset:512 sc1
  buffer_store_dword v43, v26, s[52:55], s14 offen offset:768 sc1
  s_add_u32 s14, s14, 4096
  buffer_store_dword v44, v26, s[52:55], s14 offen offset:0 sc1
  buffer_store_dword v45, v26, s[52:55], s14 offen offset:256 sc1
  buffer_store_dword v46, v26, s[52:55], s14 offen offset:512 sc1
  buffer_store_dword v47, v26, s[52:55], s14 offen offset:768 sc1
  s_add_u32 s14, s14, 4096
  buffer_store_dword v48, v26, s[52:55], s14 offen offset:0 sc1
  buffer_store_dword v49, v26, s[52:55], s14 offen offset:256 sc1
  buffer_store_dword v50, v26, s[52:55], s14 offen offset:512 sc1
  buffer_store_dword v51, v26, s[52:55], s14 offen offset:768 sc1
  s_add_u32 s14, s14, 4096
  buffer_store_dword v52, v26, s[52:55], s14 offen offset:0 sc1
  buffer_store_dword v53, v26, s[52:55], s14 offen offset:256 sc1
  buffer_store_dword v54, v26, s[52:55], s14 offen offset:512 sc1
  buffer_store_dword v55, v26, s[52:55], s14 offen offset:768 sc1
  s_add_u32 s14, s14, 4096
  buffer_store_dword v56, v26, s[52:55], s14 offen offset:0 sc1
  s_mov_b32 exec_hi, 0xffff
  buffer_store_dword v57, v26, s[52:55], s14 offen offset:256 sc1
  buffer_store_dword v58, v26, s[52:55], s14 offen offset:512 sc1
  buffer_store_dword v59, v26, s[52:55], s14 offen offset:768 sc1
  s_mov_b32 exec_hi, -1
  s_mov_b32 s80, 0x400000
K_NWG:
  ds_read_b32 v0, v3 offset:16172
  s_waitcnt lgkmcnt(0)
  v_readfirstlane_b32 s8, v0
  s_cmp_lg_u32 s8, 0
  s_cbranch_scc1 K_NWG_D
  s_sleep 2
  s_sub_u32 s80, s80, 1
  s_cbranch_scc0 K_NWG
K_NWG_D:
  v_lshlrev_b32 v27, 2, v1
  s_setprio 3
  s_mov_b64 exec, 1
  s_waitcnt vmcnt(0)
  ds_add_rtn_u32 v4, v3, v2 offset:16176
  s_mov_b32 exec_lo, -1
  s_waitcnt lgkmcnt(0)
  v_readfirstlane_b32 s8, v4
  s_cmp_lg_u32 s8, 3
  s_cbranch_scc1 K_NFL
  buffer_store_dword v0, v27, s[52:55], s12 offen sc1
K_NFL:
  s_mov_b32 exec_hi, -1
  s_setprio 1
  s_branch K_PAR
K_G2:
  s_setprio 2
  s_lshl_b32 s8, s7, 6
  v_mul_u32_u24 v20, 272, v5
  v_lshl_add_u32 v20, v2, 4, v20
  s_add_u32 s8, s8, 99280
  v_add_u32 v20, s8, v20
  v_lshrrev_b32 v6, 1, v2
  v_lshl_add_u32 v6, s7, 1, v6
  v_and_b32 v7, 7, v5
  v_xor_b32 v6, v6, v7
  v_lshlrev_b32 v6, 4, v6
  v_lshl_add_u32 v6, v5, 7, v6
  v_and_b32 v7, 1, v2
  v_lshl_add_u32 v6, v7, 3, v6
  v_add_u32 v21, 142800, v6
  v_mov_b32 v2, 1
  v_mov_b32 v22, 3217031168
  s_waitcnt vmcnt(0)
  s_mov_b32 s80, 0x400000
K_GW2:
  ds_read_b32 v0, v3 offset:16200
  s_waitcnt lgkmcnt(0)
  v_readfirstlane_b32 s8, v0
  s_cmp_ge_i32 s8, 40
  s_cbranch_scc1 K_GW2_D
  s_sleep 1
  s_sub_u32 s80, s80, 1
  s_cbranch_scc0 K_GW2
K_GW2_D:
  ds_read_b64_tr_b16 v[64:65], v58 offset:0
  ds_read_b64_tr_b16 v[66:67], v58 offset:512
  ds_read_b64_tr_b16 v[96:97], v58 offset:32768
  ds_read_b64_tr_b16 v[98:99], v58 offset:33280
  ds_read_b128 v[24:27], v60 offset:0
  ds_read_b64_tr_b16 v[68:69], v58 offset:4096
  ds_read_b64_tr_b16 v[70:71], v58 offset:4608
  ds_read_b64_tr_b16 v[100:101], v58 offset:36864
  ds_read_b64_tr_b16 v[102:103], v58 offset:37376
  ds_read_b128 v[28:31], v61 offset:0
  ds_read_b64_tr_b16 v[72:73], v58 offset:8192
  ds_read_b64_tr_b16 v[74:75], v58 offset:8704
  ds_read_b64_tr_b16 v[104:105], v58 offset:40960
  ds_read_b64_tr_b16 v[106:107], v58 offset:41472
  ds_read_b128 v[32:35], v62 offset:0
  s_waitcnt lgkmcnt(10)
  v_mfma_f32_16x16x32_bf16 v[4:7], v[64:67], v[24:27], 0
  v_mfma_f32_16x16x32_bf16 v[8:11], v[96:99], v[24:27], 0
  ds_read_b64_tr_b16 v[76:77], v58 offset:12288
  ds_read_b64_tr_b16 v[78:79], v58 offset:12800
  ds_read_b64_tr_b16 v[108:109], v58 offset:45056
  ds_read_b64_tr_b16 v[110:111], v58 offset:45568
  ds_read_b128 v[36:39], v63 offset:0
  s_waitcnt lgkmcnt(10)
  v_mfma_f32_16x16x32_bf16 v[4:7], v[68:71], v[28:31], v[4:7]
  v_mfma_f32_16x16x32_bf16 v[8:11], v[100:103], v[28:31], v[8:11]
  ds_read_b64_tr_b16 v[80:81], v58 offset:16384
  ds_read_b64_tr_b16 v[82:83], v58 offset:16896
  ds_read_b64_tr_b16 v[112:113], v58 offset:49152
  ds_read_b64_tr_b16 v[114:115], v58 offset:49664
  ds_read_b128 v[40:43], v60 offset:256
  s_waitcnt lgkmcnt(10)
  v_mfma_f32_16x16x32_bf16 v[4:7], v[72:75], v[32:35], v[4:7]
  v_mfma_f32_16x16x32_bf16 v[8:11], v[104:107], v[32:35], v[8:11]
  ds_read_b64_tr_b16 v[84:85], v58 offset:20480
  ds_read_b64_tr_b16 v[86:87], v58 offset:20992
  ds_read_b64_tr_b16 v[116:117], v58 offset:53248
  ds_read_b64_tr_b16 v[118:119], v58 offset:53760
  ds_read_b128 v[44:47], v61 offset:256
  s_waitcnt lgkmcnt(10)
  v_mfma_f32_16x16x32_bf16 v[4:7], v[76:79], v[36:39], v[4:7]
  v_mfma_f32_16x16x32_bf16 v[8:11], v[108:111], v[36:39], v[8:11]
  ds_read_b64_tr_b16 v[88:89], v58 offset:24576
  ds_read_b64_tr_b16 v[90:91], v58 offset:25088
  ds_read_b64_tr_b16 v[120:121], v58 offset:57344
  ds_read_b64_tr_b16 v[122:123], v58 offset:57856
  ds_read_b128 v[48:51], v62 offset:256
  s_waitcnt lgkmcnt(10)
  v_mfma_f32_16x16x32_bf16 v[4:7], v[80:83], v[40:43], v[4:7]
  v_mfma_f32_16x16x32_bf16 v[8:11], v[112:115], v[40:43], v[8:11]
  ds_read_b64_tr_b16 v[92:93], v58 offset:28672
  ds_read_b64_tr_b16 v[94:95], v58 offset:29184
  ds_read_b64_tr_b16 v[124:125], v58 offset:61440
  ds_read_b64_tr_b16 v[126:127], v58 offset:61952
  ds_read_b128 v[52:55], v63 offset:256
  s_mov_b64 exec, 1
  ds_add_u32 v3, v2 offset:16168
  s_mov_b64 exec, -1
  s_waitcnt lgkmcnt(11)
  v_mfma_f32_16x16x32_bf16 v[4:7], v[84:87], v[44:47], v[4:7]
  v_mfma_f32_16x16x32_bf16 v[8:11], v[116:119], v[44:47], v[8:11]
  ds_read_b128 v[24:27], v60 offset:8192
  ds_read_b128 v[28:31], v61 offset:8192
  ds_read_b128 v[32:35], v62 offset:8192
  s_waitcnt lgkmcnt(9)
  v_mfma_f32_16x16x32_bf16 v[4:7], v[88:91], v[48:51], v[4:7]
  v_mfma_f32_16x16x32_bf16 v[8:11], v[120:123], v[48:51], v[8:11]
  ds_read_b128 v[36:39], v63 offset:8192
  ds_read_b128 v[40:43], v60 offset:8448
  ds_read_b128 v[44:47], v61 offset:8448
  s_waitcnt lgkmcnt(7)
  v_mfma_f32_16x16x32_bf16 v[4:7], v[92:95], v[52:55], v[4:7]
  v_mfma_f32_16x16x32_bf16 v[8:11], v[124:127], v[52:55], v[8:11]
  ds_read_b128 v[48:51], v62 offset:8448
  s_waitcnt lgkmcnt(5)
  v_mfma_f32_16x16x32_bf16 v[12:15], v[64:67], v[24:27], 0
  ds_read_b128 v[52:55], v63 offset:8448
  v_mfma_f32_16x16x32_bf16 v[16:19], v[96:99], v[24:27], 0
  ds_read_b32 v23, v3 offset:16168
  v_mfma_f32_16x16x32_bf16 v[12:15], v[68:71], v[28:31], v[12:15]
  s_waitcnt lgkmcnt(5)
  ds_read_b128 v[24:27], v60 offset:16384
  v_mfma_f32_16x16x32_bf16 v[16:19], v[100:103], v[28:31], v[16:19]
  v_mfma_f32_16x16x32_bf16 v[12:15], v[72:75], v[32:35], v[12:15]
  ds_read_b128 v[28:31], v61 offset:16384
  v_mfma_f32_16x16x32_bf16 v[16:19], v[104:107], v[32:35], v[16:19]
  v_fma_f32 v4, v4, s72, v22
  v_fma_f32 v5, v5, s72, v22
  v_mfma_f32_16x16x32_bf16 v[12:15], v[76:79], v[36:39], v[12:15]
  s_waitcnt lgkmcnt(5)
  ds_read_b128 v[32:35], v62 offset:16384
  v_mfma_f32_16x16x32_bf16 v[16:19], v[108:111], v[36:39], v[16:19]
  v_fma_f32 v6, v6, s72, v22
  v_fma_f32 v7, v7, s72, v22
  v_mfma_f32_16x16x32_bf16 v[12:15], v[80:83], v[40:43], v[12:15]
  ds_read_b128 v[36:39], v63 offset:16384
  v_mfma_f32_16x16x32_bf16 v[16:19], v[112:115], v[40:43], v[16:19]
  v_cvt_pk_bf16_f32 v8, v8, v9
  v_cvt_pk_bf16_f32 v9, v10, v11
  v_mfma_f32_16x16x32_bf16 v[12:15], v[84:87], v[44:47], v[12:15]
  s_waitcnt lgkmcnt(5)
  ds_read_b128 v[40:43], v60 offset:16640
  v_mfma_f32_16x16x32_bf16 v[16:19], v[116:119], v[44:47], v[16:19]
  s_waitcnt lgkmcnt(5)
  v_readfirstlane_b32 s8, v23
  s_cmp_lt_u32 s8, 4
  s_cbranch_scc1 K_WC2W
K_WC2K:
  ds_write_b128 v20, v[4:7] offset:0
  v_mfma_f32_16x16x32_bf16 v[12:15], v[88:91], v[48:51], v[12:15]
  ds_read_b128 v[44:47], v61 offset:16640
  v_mfma_f32_16x16x32_bf16 v[16:19], v[120:123], v[48:51], v[16:19]
  ds_write_b64 v21, v[8:9] offset:0
  v_mfma_f32_16x16x32_bf16 v[12:15], v[92:95], v[52:55], v[12:15]
  s_waitcnt lgkmcnt(6)
  ds_read_b128 v[48:51], v62 offset:16640
  v_mfma_f32_16x16x32_bf16 v[16:19], v[124:127], v[52:55], v[16:19]
  v_mfma_f32_16x16x32_bf16 v[4:7], v[64:67], v[24:27], 0
  ds_read_b128 v[52:55], v63 offset:16640
  v_mfma_f32_16x16x32_bf16 v[8:11], v[96:99], v[24:27], 0
  v_mfma_f32_16x16x32_bf16 v[4:7], v[68:71], v[28:31], v[4:7]
  s_waitcnt lgkmcnt(6)
  ds_read_b128 v[24:27], v60 offset:24576
  v_mfma_f32_16x16x32_bf16 v[8:11], v[100:103], v[28:31], v[8:11]
  v_mfma_f32_16x16x32_bf16 v[4:7], v[72:75], v[32:35], v[4:7]
  ds_read_b128 v[28:31], v61 offset:24576
  v_mfma_f32_16x16x32_bf16 v[8:11], v[104:107], v[32:35], v[8:11]
  v_fma_f32 v12, v12, s72, v22
  v_fma_f32 v13, v13, s72, v22
  v_mfma_f32_16x16x32_bf16 v[4:7], v[76:79], v[36:39], v[4:7]
  s_waitcnt lgkmcnt(5)
  ds_read_b128 v[32:35], v62 offset:24576
  v_mfma_f32_16x16x32_bf16 v[8:11], v[108:111], v[36:39], v[8:11]
  v_fma_f32 v14, v14, s72, v22
  v_fma_f32 v15, v15, s72, v22
  v_mfma_f32_16x16x32_bf16 v[4:7], v[80:83], v[40:43], v[4:7]
  ds_read_b128 v[36:39], v63 offset:24576
  v_mfma_f32_16x16x32_bf16 v[8:11], v[112:115], v[40:43], v[8:11]
  v_cvt_pk_bf16_f32 v16, v16, v17
  v_cvt_pk_bf16_f32 v17, v18, v19
  v_mfma_f32_16x16x32_bf16 v[4:7], v[84:87], v[44:47], v[4:7]
  s_waitcnt lgkmcnt(4)
  ds_read_b128 v[40:43], v60 offset:24832
  v_mfma_f32_16x16x32_bf16 v[8:11], v[116:119], v[44:47], v[8:11]
  ds_write_b128 v20, v[12:15] offset:4352
  v_mfma_f32_16x16x32_bf16 v[4:7], v[88:91], v[48:51], v[4:7]
  ds_read_b128 v[44:47], v61 offset:24832
  v_mfma_f32_16x16x32_bf16 v[8:11], v[120:123], v[48:51], v[8:11]
  ds_write_b64 v21, v[16:17] offset:2048
  v_mfma_f32_16x16x32_bf16 v[4:7], v[92:95], v[52:55], v[4:7]
  s_waitcnt lgkmcnt(6)
  ds_read_b128 v[48:51], v62 offset:24832
  v_mfma_f32_16x16x32_bf16 v[8:11], v[124:127], v[52:55], v[8:11]
  v_mfma_f32_16x16x32_bf16 v[12:15], v[64:67], v[24:27], 0
  ds_read_b128 v[52:55], v63 offset:24832
  v_mfma_f32_16x16x32_bf16 v[16:19], v[96:99], v[24:27], 0
  v_mfma_f32_16x16x32_bf16 v[12:15], v[68:71], v[28:31], v[12:15]
  s_waitcnt lgkmcnt(6)
  ds_read_b128 v[24:27], v60 offset:32768
  v_mfma_f32_16x16x32_bf16 v[16:19], v[100:103], v[28:31], v[16:19]
  v_mfma_f32_16x16x32_bf16 v[12:15], v[72:75], v[32:35], v[12:15]
  ds_read_b128 v[28:31], v61 offset:32768
  v_mfma_f32_16x16x32_bf16 v[16:19], v[104:107], v[32:35], v[16:19]
  v_fma_f32 v4, v4, s72, v22
  v_fma_f32 v5, v5, s72, v22
  v_mfma_f32_16x16x32_bf16 v[12:15], v[76:79], v[36:39], v[12:15]
  s_waitcnt lgkmcnt(5)
  ds_read_b128 v[32:35], v62 offset:32768
  v_mfma_f32_16x16x32_bf16 v[16:19], v[108:111], v[36:39], v[16:19]
  v_fma_f32 v6, v6, s72, v22
  v_fma_f32 v7, v7, s72, v22
  v_mfma_f32_16x16x32_bf16 v[12:15], v[80:83], v[40:43], v[12:15]
  ds_read_b128 v[36:39], v63 offset:32768
  v_mfma_f32_16x16x32_bf16 v[16:19], v[112:115], v[40:43], v[16:19]
  v_cvt_pk_bf16_f32 v8, v8, v9
  v_cvt_pk_bf16_f32 v9, v10, v11
  v_mfma_f32_16x16x32_bf16 v[12:15], v[84:87], v[44:47], v[12:15]
  s_waitcnt lgkmcnt(4)
  ds_read_b128 v[40:43], v60 offset:33024
  v_mfma_f32_16x16x32_bf16 v[16:19], v[116:119], v[44:47], v[16:19]
  ds_write_b128 v20, v[4:7] offset:8704
  v_mfma_f32_16x16x32_bf16 v[12:15], v[88:91], v[48:51], v[12:15]
  ds_read_b128 v[44:47], v61 offset:33024
  v_mfma_f32_16x16x32_bf16 v[16:19], v[120:123], v[48:51], v[16:19]
  ds_write_b64 v21, v[8:9] offset:4096
  v_mfma_f32_16x16x32_bf16 v[12:15], v[92:95], v[52:55], v[12:15]
  s_waitcnt lgkmcnt(6)
  ds_read_b128 v[48:51], v62 offset:33024
  v_mfma_f32_16x16x32_bf16 v[16:19], v[124:127], v[52:55], v[16:19]
  v_mfma_f32_16x16x32_bf16 v[4:7], v[64:67], v[24:27], 0
  ds_read_b128 v[52:55], v63 offset:33024
  v_mfma_f32_16x16x32_bf16 v[8:11], v[96:99], v[24:27], 0
  v_mfma_f32_16x16x32_bf16 v[4:7], v[68:71], v[28:31], v[4:7]
  s_waitcnt lgkmcnt(6)
  ds_read_b128 v[24:27], v60 offset:40960
  v_mfma_f32_16x16x32_bf16 v[8:11], v[100:103], v[28:31], v[8:11]
  v_mfma_f32_16x16x32_bf16 v[4:7], v[72:75], v[32:35], v[4:7]
  ds_read_b128 v[28:31], v61 offset:40960
  v_mfma_f32_16x16x32_bf16 v[8:11], v[104:107], v[32:35], v[8:11]
  v_fma_f32 v12, v12, s72, v22
  v_fma_f32 v13, v13, s72, v22
  v_mfma_f32_16x16x32_bf16 v[4:7], v[76:79], v[36:39], v[4:7]
  s_waitcnt lgkmcnt(5)
  ds_read_b128 v[32:35], v62 offset:40960
  v_mfma_f32_16x16x32_bf16 v[8:11], v[108:111], v[36:39], v[8:11]
  v_fma_f32 v14, v14, s72, v22
  v_fma_f32 v15, v15, s72, v22
  v_mfma_f32_16x16x32_bf16 v[4:7], v[80:83], v[40:43], v[4:7]
  ds_read_b128 v[36:39], v63 offset:40960
  v_mfma_f32_16x16x32_bf16 v[8:11], v[112:115], v[40:43], v[8:11]
  v_cvt_pk_bf16_f32 v16, v16, v17
  v_cvt_pk_bf16_f32 v17, v18, v19
  v_mfma_f32_16x16x32_bf16 v[4:7], v[84:87], v[44:47], v[4:7]
  s_waitcnt lgkmcnt(4)
  ds_read_b128 v[40:43], v60 offset:41216
  v_mfma_f32_16x16x32_bf16 v[8:11], v[116:119], v[44:47], v[8:11]
  ds_write_b128 v20, v[12:15] offset:13056
  v_mfma_f32_16x16x32_bf16 v[4:7], v[88:91], v[48:51], v[4:7]
  ds_read_b128 v[44:47], v61 offset:41216
  v_mfma_f32_16x16x32_bf16 v[8:11], v[120:123], v[48:51], v[8:11]
  ds_write_b64 v21, v[16:17] offset:6144
  v_mfma_f32_16x16x32_bf16 v[4:7], v[92:95], v[52:55], v[4:7]
  s_waitcnt lgkmcnt(6)
  ds_read_b128 v[48:51], v62 offset:41216
  v_mfma_f32_16x16x32_bf16 v[8:11], v[124:127], v[52:55], v[8:11]
  v_mfma_f32_16x16x32_bf16 v[12:15], v[64:67], v[24:27], 0
  ds_read_b128 v[52:55], v63 offset:41216
  v_mfma_f32_16x16x32_bf16 v[16:19], v[96:99], v[24:27], 0
  v_mfma_f32_16x16x32_bf16 v[12:15], v[68:71], v[28:31], v[12:15]
  s_waitcnt lgkmcnt(6)
  ds_read_b128 v[24:27], v60 offset:49152
  v_mfma_f32_16x16x32_bf16 v[16:19], v[100:103], v[28:31], v[16:19]
  v_mfma_f32_16x16x32_bf16 v[12:15], v[72:75], v[32:35], v[12:15]
  ds_read_b128 v[28:31], v61 offset:49152
  v_mfma_f32_16x16x32_bf16 v[16:19], v[104:107], v[32:35], v[16:19]
  v_fma_f32 v4, v4, s72, v22
  v_fma_f32 v5, v5, s72, v22
  v_mfma_f32_16x16x32_bf16 v[12:15], v[76:79], v[36:39], v[12:15]
  s_waitcnt lgkmcnt(5)
  ds_read_b128 v[32:35], v62 offset:49152
  v_mfma_f32_16x16x32_bf16 v[16:19], v[108:111], v[36:39], v[16:19]
  v_fma_f32 v6, v6, s72, v22
  v_fma_f32 v7, v7, s72, v22
  v_mfma_f32_16x16x32_bf16 v[12:15], v[80:83], v[40:43], v[12:15]
  ds_read_b128 v[36:39], v63 offset:49152
  v_mfma_f32_16x16x32_bf16 v[16:19], v[112:115], v[40:43], v[16:19]
  v_cvt_pk_bf16_f32 v8, v8, v9
  v_cvt_pk_bf16_f32 v9, v10, v11
  v_mfma_f32_16x16x32_bf16 v[12:15], v[84:87], v[44:47], v[12:15]
  s_waitcnt lgkmcnt(4)
  ds_read_b128 v[40:43], v60 offset:49408
  v_mfma_f32_16x16x32_bf16 v[16:19], v[116:119], v[44:47], v[16:19]
  ds_write_b128 v20, v[4:7] offset:17408
  v_mfma_f32_16x16x32_bf16 v[12:15], v[88:91], v[48:51], v[12:15]
  ds_read_b128 v[44:47], v61 offset:49408
  v_mfma_f32_16x16x32_bf16 v[16:19], v[120:123], v[48:51], v[16:19]
  ds_write_b64 v21, v[8:9] offset:8192
  v_mfma_f32_16x16x32_bf16 v[12:15], v[92:95], v[52:55], v[12:15]
  s_waitcnt lgkmcnt(6)
  ds_read_b128 v[48:51], v62 offset:49408
  v_mfma_f32_16x16x32_bf16 v[16:19], v[124:127], v[52:55], v[16:19]
  v_mfma_f32_16x16x32_bf16 v[4:7], v[64:67], v[24:27], 0
  ds_read_b128 v[52:55], v63 offset:49408
  v_mfma_f32_16x16x32_bf16 v[8:11], v[96:99], v[24:27], 0
  v_mfma_f32_16x16x32_bf16 v[4:7], v[68:71], v[28:31], v[4:7]
  s_waitcnt lgkmcnt(6)
  ds_read_b128 v[24:27], v60 offset:57344
  v_mfma_f32_16x16x32_bf16 v[8:11], v[100:103], v[28:31], v[8:11]
  v_mfma_f32_16x16x32_bf16 v[4:7], v[72:75], v[32:35], v[4:7]
  ds_read_b128 v[28:31], v61 offset:57344
  v_mfma_f32_16x16x32_bf16 v[8:11], v[104:107], v[32:35], v[8:11]
  v_fma_f32 v12, v12, s72, v22
  v_fma_f32 v13, v13, s72, v22
  v_mfma_f32_16x16x32_bf16 v[4:7], v[76:79], v[36:39], v[4:7]
  s_waitcnt lgkmcnt(5)
  ds_read_b128 v[32:35], v62 offset:57344
  v_mfma_f32_16x16x32_bf16 v[8:11], v[108:111], v[36:39], v[8:11]
  v_fma_f32 v14, v14, s72, v22
  v_fma_f32 v15, v15, s72, v22
  v_mfma_f32_16x16x32_bf16 v[4:7], v[80:83], v[40:43], v[4:7]
  ds_read_b128 v[36:39], v63 offset:57344
  v_mfma_f32_16x16x32_bf16 v[8:11], v[112:115], v[40:43], v[8:11]
  v_cvt_pk_bf16_f32 v16, v16, v17
  v_cvt_pk_bf16_f32 v17, v18, v19
  v_mfma_f32_16x16x32_bf16 v[4:7], v[84:87], v[44:47], v[4:7]
  s_waitcnt lgkmcnt(4)
  ds_read_b128 v[40:43], v60 offset:57600
  v_mfma_f32_16x16x32_bf16 v[8:11], v[116:119], v[44:47], v[8:11]
  ds_write_b128 v20, v[12:15] offset:21760
  v_mfma_f32_16x16x32_bf16 v[4:7], v[88:91], v[48:51], v[4:7]
  ds_read_b128 v[44:47], v61 offset:57600
  v_mfma_f32_16x16x32_bf16 v[8:11], v[120:123], v[48:51], v[8:11]
  ds_write_b64 v21, v[16:17] offset:10240
  v_mfma_f32_16x16x32_bf16 v[4:7], v[92:95], v[52:55], v[4:7]
  s_waitcnt lgkmcnt(6)
  ds_read_b128 v[48:51], v62 offset:57600
  v_mfma_f32_16x16x32_bf16 v[8:11], v[124:127], v[52:55], v[8:11]
  v_mfma_f32_16x16x32_bf16 v[12:15], v[64:67], v[24:27], 0
  ds_read_b128 v[52:55], v63 offset:57600
  v_mfma_f32_16x16x32_bf16 v[16:19], v[96:99], v[24:27], 0
  v_add_u32 v60, 0x10000, v60
  v_add_u32 v61, 0x10000, v61
  v_mfma_f32_16x16x32_bf16 v[12:15], v[68:71], v[28:31], v[12:15]
  s_waitcnt lgkmcnt(6)
  ds_read_b128 v[24:27], v60 offset:0
  v_mfma_f32_16x16x32_bf16 v[16:19], v[100:103], v[28:31], v[16:19]
  v_add_u32 v62, 0x10000, v62
  v_add_u32 v63, 0x10000, v63
  v_mfma_f32_16x16x32_bf16 v[12:15], v[72:75], v[32:35], v[12:15]
  ds_read_b128 v[28:31], v61 offset:0
  v_mfma_f32_16x16x32_bf16 v[16:19], v[104:107], v[32:35], v[16:19]
  v_fma_f32 v4, v4, s72, v22
  v_fma_f32 v5, v5, s72, v22
  v_mfma_f32_16x16x32_bf16 v[12:15], v[76:79], v[36:39], v[12:15]
  s_waitcnt lgkmcnt(5)
  ds_read_b128 v[32:35], v62 offset:0
  v_mfma_f32_16x16x32_bf16 v[16:19], v[108:111], v[36:39], v[16:19]
  v_fma_f32 v6, v6, s72, v22
  v_fma_f32 v7, v7, s72, v22
  v_mfma_f32_16x16x32_bf16 v[12:15], v[80:83], v[40:43], v[12:15]
  ds_read_b128 v[36:39], v63 offset:0
  v_mfma_f32_16x16x32_bf16 v[16:19], v[112:115], v[40:43], v[16:19]
  v_cvt_pk_bf16_f32 v8, v8, v9
  v_cvt_pk_bf16_f32 v9, v10, v11
  v_mfma_f32_16x16x32_bf16 v[12:15], v[84:87], v[44:47], v[12:15]
  s_waitcnt lgkmcnt(4)
  ds_read_b128 v[40:43], v60 offset:256
  v_mfma_f32_16x16x32_bf16 v[16:19], v[116:119], v[44:47], v[16:19]
  ds_write_b128 v20, v[4:7] offset:26112
  v_mfma_f32_16x16x32_bf16 v[12:15], v[88:91], v[48:51], v[12:15]
  ds_read_b128 v[44:47], v61 offset:256
  v_mfma_f32_16x16x32_bf16 v[16:19], v[120:123], v[48:51], v[16:19]
  ds_write_b64 v21, v[8:9] offset:12288
  v_mfma_f32_16x16x32_bf16 v[12:15], v[92:95], v[52:55], v[12:15]
  s_waitcnt lgkmcnt(6)
  ds_read_b128 v[48:51], v62 offset:256
  v_mfma_f32_16x16x32_bf16 v[16:19], v[124:127], v[52:55], v[16:19]
  v_mfma_f32_16x16x32_bf16 v[4:7], v[64:67], v[24:27], 0
  ds_read_b128 v[52:55], v63 offset:256
  v_mfma_f32_16x16x32_bf16 v[8:11], v[96:99], v[24:27], 0
  v_mfma_f32_16x16x32_bf16 v[4:7], v[68:71], v[28:31], v[4:7]
  s_waitcnt lgkmcnt(6)
  ds_read_b128 v[24:27], v60 offset:8192
  v_mfma_f32_16x16x32_bf16 v[8:11], v[100:103], v[28:31], v[8:11]
  v_mfma_f32_16x16x32_bf16 v[4:7], v[72:75], v[32:35], v[4:7]
  ds_read_b128 v[28:31], v61 offset:8192
  v_mfma_f32_16x16x32_bf16 v[8:11], v[104:107], v[32:35], v[8:11]
  v_fma_f32 v12, v12, s72, v22
  v_fma_f32 v13, v13, s72, v22
  v_mfma_f32_16x16x32_bf16 v[4:7], v[76:79], v[36:39], v[4:7]
  s_waitcnt lgkmcnt(5)
  ds_read_b128 v[32:35], v62 offset:8192
  v_mfma_f32_16x16x32_bf16 v[8:11], v[108:111], v[36:39], v[8:11]
  v_fma_f32 v14, v14, s72, v22
  v_fma_f32 v15, v15, s72, v22
  v_mfma_f32_16x16x32_bf16 v[4:7], v[80:83], v[40:43], v[4:7]
  ds_read_b128 v[36:39], v63 offset:8192
  v_mfma_f32_16x16x32_bf16 v[8:11], v[112:115], v[40:43], v[8:11]
  v_cvt_pk_bf16_f32 v16, v16, v17
  v_cvt_pk_bf16_f32 v17, v18, v19
  v_mfma_f32_16x16x32_bf16 v[4:7], v[84:87], v[44:47], v[4:7]
  s_waitcnt lgkmcnt(4)
  ds_read_b128 v[40:43], v60 offset:8448
  v_mfma_f32_16x16x32_bf16 v[8:11], v[116:119], v[44:47], v[8:11]
  ds_write_b128 v20, v[12:15] offset:30464
  v_mfma_f32_16x16x32_bf16 v[4:7], v[88:91], v[48:51], v[4:7]
  ds_read_b128 v[44:47], v61 offset:8448
  v_mfma_f32_16x16x32_bf16 v[8:11], v[120:123], v[48:51], v[8:11]
  ds_write_b64 v21, v[16:17] offset:14336
  v_mfma_f32_16x16x32_bf16 v[4:7], v[92:95], v[52:55], v[4:7]
  s_waitcnt lgkmcnt(6)
  ds_read_b128 v[48:51], v62 offset:8448
  v_mfma_f32_16x16x32_bf16 v[8:11], v[124:127], v[52:55], v[8:11]
  v_mfma_f32_16x16x32_bf16 v[12:15], v[64:67], v[24:27], 0
  ds_read_b128 v[52:55], v63 offset:8448
  v_mfma_f32_16x16x32_bf16 v[16:19], v[96:99], v[24:27], 0
  v_mfma_f32_16x16x32_bf16 v[12:15], v[68:71], v[28:31], v[12:15]
  s_waitcnt lgkmcnt(6)
  v_mfma_f32_16x16x32_bf16 v[16:19], v[100:103], v[28:31], v[16:19]
  v_mfma_f32_16x16x32_bf16 v[12:15], v[72:75], v[32:35], v[12:15]
  v_mfma_f32_16x16x32_bf16 v[16:19], v[104:107], v[32:35], v[16:19]
  v_fma_f32 v4, v4, s72, v22
  v_fma_f32 v5, v5, s72, v22
  v_mfma_f32_16x16x32_bf16 v[12:15], v[76:79], v[36:39], v[12:15]
  s_waitcnt lgkmcnt(3)
  v_mfma_f32_16x16x32_bf16 v[16:19], v[108:111], v[36:39], v[16:19]
  v_fma_f32 v6, v6, s72, v22
  v_fma_f32 v7, v7, s72, v22
  v_mfma_f32_16x16x32_bf16 v[12:15], v[80:83], v[40:43], v[12:15]
  v_mfma_f32_16x16x32_bf16 v[16:19], v[112:115], v[40:43], v[16:19]
  v_cvt_pk_bf16_f32 v8, v8, v9
  v_cvt_pk_bf16_f32 v9, v10, v11
  v_mfma_f32_16x16x32_bf16 v[12:15], v[84:87], v[44:47], v[12:15]
  s_waitcnt lgkmcnt(0)
  v_mfma_f32_16x16x32_bf16 v[16:19], v[116:119], v[44:47], v[16:19]
  ds_write_b128 v20, v[4:7] offset:34816
  v_mfma_f32_16x16x32_bf16 v[12:15], v[88:91], v[48:51], v[12:15]
  v_mfma_f32_16x16x32_bf16 v[16:19], v[120:123], v[48:51], v[16:19]
  ds_write_b64 v21, v[8:9] offset:16384
  v_mfma_f32_16x16x32_bf16 v[12:15], v[92:95], v[52:55], v[12:15]
  v_mfma_f32_16x16x32_bf16 v[16:19], v[124:127], v[52:55], v[16:19]
  v_mov_b32 v2, 0x100
  s_nop 5
  v_fma_f32 v12, v12, s72, v22
  v_fma_f32 v13, v13, s72, v22
  v_fma_f32 v14, v14, s72, v22
  v_fma_f32 v15, v15, s72, v22
  v_cvt_pk_bf16_f32 v16, v16, v17
  v_cvt_pk_bf16_f32 v17, v18, v19
  ds_write_b128 v20, v[12:15] offset:39168
  ds_write_b64 v21, v[16:17] offset:18432
  s_mov_b64 exec, 1
  ds_add_u32 v3, v2 offset:16224
  s_mov_b64 exec, -1
  s_setprio 3
  s_branch K_PAR
K_H15:
  v_mov_b64 v[8:9], s[76:77]
  s_mov_b64 exec, 1
  ds_write_b64 v3, v[8:9] offset:16208
  ds_write_b64 v3, v[8:9] offset:16216
  s_mov_b64 exec, -1
  v_lshlrev_b32 v6, 1, v1
  s_lshl_b32 s9, s4, 7
  buffer_load_ushort v7, v6, s[68:71], s9 offen
  v_lshlrev_b32 v6, 2, v1
  v_lshlrev_b32 v5, 4, v1
  v_mov_b32 v40, 40
  v_writelane_b32 v40, 0, 1
  v_writelane_b32 v40, 27, 2
  v_writelane_b32 v40, 1, 5
  v_writelane_b32 v40, 15, 6
  v_writelane_b32 v40, 2, 9
  v_writelane_b32 v40, 14, 10
  v_writelane_b32 v40, 3, 13
  v_writelane_b32 v40, 12, 14
  v_writelane_b32 v40, 13, 17
  v_writelane_b32 v40, 21, 18
  v_writelane_b32 v40, 39, 19
  v_writelane_b32 v40, 22, 21
  v_writelane_b32 v40, 29, 22
  v_writelane_b32 v40, 33, 23
  v_writelane_b32 v40, 19, 25
  v_writelane_b32 v40, 30, 26
  v_writelane_b32 v40, 34, 27
  v_writelane_b32 v40, 18, 29
  v_writelane_b32 v40, 28, 30
  v_writelane_b32 v40, 35, 31
  v_writelane_b32 v40, 23, 33
  v_writelane_b32 v40, 31, 34
  v_writelane_b32 v40, 32, 35
  v_writelane_b32 v40, 7, 37
  v_writelane_b32 v40, 8, 38
  v_writelane_b32 v40, 5, 41
  v_writelane_b32 v40, 10, 42
  v_writelane_b32 v40, 4, 45
  v_writelane_b32 v40, 11, 46
  v_writelane_b32 v40, 6, 49
  v_writelane_b32 v40, 9, 50
  v_writelane_b32 v40, 16, 53
  v_writelane_b32 v40, 24, 54
  v_writelane_b32 v40, 38, 55
  v_writelane_b32 v40, 17, 57
  v_writelane_b32 v40, 25, 58
  v_writelane_b32 v40, 37, 59
  v_writelane_b32 v40, 20, 61
  v_writelane_b32 v40, 26, 62
  v_writelane_b32 v40, 36, 63
  v_lshlrev_b32 v40, 2, v40
  v_mov_b32 v41, v1
  v_add_u32 v42, 64, v1
  v_add_u32 v43, 0x80, v1
  v_mov_b32 v44, 4096
  s_movk_i32 s10, 252
  s_mov_b32 s12, 0x11111111
  s_mov_b32 s13, 0x11111111
  s_waitcnt vmcnt(0)
  v_lshlrev_b32 v7, 16, v7
  v_mul_f32 v7, s72, v7
  s_setprio 3
  s_mov_b32 s80, 0x400000
K_RKW:
  ds_read_b32 v4, v3 offset:16184
  s_waitcnt lgkmcnt(0)
  v_readfirstlane_b32 s8, v4
  s_cmp_ge_u32 s8, 1
  s_cbranch_scc1 K_RKW_D
  s_sleep 1
  s_sub_u32 s80, s80, 1
  s_cbranch_scc0 K_RKW
K_RKW_D:
K_RKQ:
  ds_read_b32 v4, v3 offset:16184
  ds_read_b128 v[24:27], v5 offset:0
  ds_read_b128 v[28:31], v5 offset:1024
  ds_read_b128 v[32:35], v5 offset:2048
  s_sub_u32 s80, s80, 1
  s_cbranch_scc1 K_RKQD
  s_waitcnt lgkmcnt(3)
  v_readfirstlane_b32 s8, v4
  s_cmp_lt_u32 s8, 4
  s_cbranch_scc1 K_RKQ
K_RKQD:
  s_waitcnt lgkmcnt(2)
  v_add3_u32 v25, v27, v26, v25
  v_add_u32 v8, v25, v24
  v_med3_u32 v8, v8, 1, 63
  v_mad_i32_i24 v12, v8, -4, s10
  ds_add_rtn_u32 v16, v12, v2 offset:2816
  s_waitcnt lgkmcnt(2)
  v_add3_u32 v29, v31, v30, v29
  v_add_u32 v9, v29, v28
  v_med3_u32 v9, v9, 1, 63
  v_mad_i32_i24 v13, v9, -4, s10
  ds_add_rtn_u32 v17, v13, v2 offset:2816
  s_waitcnt lgkmcnt(2)
  v_add3_u32 v33, v35, v34, v33
  v_add_u32 v10, v33, v32
  v_med3_u32 v10, v10, 1, 63
  v_mad_i32_i24 v14, v10, -4, s10
  s_mov_b32 exec_hi, 0
  ds_add_rtn_u32 v18, v14, v2 offset:2816
  s_mov_b32 exec_hi, -1
  ds_read_b32 v36, v6 offset:2816
  ds_write_b32 v6, v7 offset:2560
  v_add_u32 v26, v27, v26
  v_mov_b32 v48, v27
  v_add_u32 v30, v31, v30
  v_mov_b32 v49, v31
  v_add_u32 v34, v35, v34
  v_mov_b32 v50, v35
  s_waitcnt lgkmcnt(1)
  v_mov_b32 v37, v36
  v_readfirstlane_b32 s11, v36
  s_nop 0
  v_add_u32_dpp v37, v37, v37 row_shr:1 row_mask:0xf bank_mask:0xf bound_ctrl:0
  s_nop 1
  v_add_u32_dpp v37, v37, v37 row_shr:2 row_mask:0xf bank_mask:0xf bound_ctrl:0
  s_nop 1
  v_add_u32_dpp v37, v37, v37 row_shr:4 row_mask:0xf bank_mask:0xf bound_ctrl:0
  s_nop 1
  v_add_u32_dpp v37, v37, v37 row_shr:8 row_mask:0xf bank_mask:0xf bound_ctrl:0
  s_nop 1
  v_add_u32_dpp v37, v37, v37 row_bcast:15 row_mask:0xa bank_mask:0xf
  s_nop 1
  v_add_u32_dpp v37, v37, v37 row_bcast:31 row_mask:0xc bank_mask:0xf
  v_sub_u32 v37, v37, v36
  ds_bpermute_b32 v20, v12, v37
  ds_bpermute_b32 v21, v13, v37
  ds_bpermute_b32 v22, v14, v37
  s_waitcnt lgkmcnt(2)
  v_add_u32 v20, v20, v16
  ds_write_b8 v20, v8 offset:3248
  ds_write_b8 v20, v41 offset:3072
  s_waitcnt lgkmcnt(3)
  v_add_u32 v21, v21, v17
  ds_write_b8 v21, v9 offset:3248
  ds_write_b8 v21, v42 offset:3072
  s_waitcnt lgkmcnt(4)
  v_add_u32 v22, v22, v18
  s_mov_b32 exec_hi, 0
  ds_write_b8 v22, v10 offset:3248
  ds_write_b8 v22, v43 offset:3072
  s_mov_b32 exec_hi, -1
  ds_read_b32 v36, v40 offset:3248
  ds_read_b32 v38, v40 offset:3072
  v_and_b32 v12, 3, v20
  v_and_b32 v20, 0xfc, v20
  v_mad_i32_i24 v12, v8, -4, v12
  v_and_b32 v13, 3, v21
  v_and_b32 v21, 0xfc, v21
  v_mad_i32_i24 v13, v9, -4, v13
  v_and_b32 v14, 3, v22
  v_and_b32 v22, 0xfc, v22
  v_mad_i32_i24 v14, v10, -4, v14
  s_waitcnt lgkmcnt(1)
  v_and_b32 v37, 0xff, v36
  v_lshrrev_b32 v39, 8, v36
  s_nop 0
  v_add_u32_dpp v37, v37, v37 row_shr:1 row_mask:0xf bank_mask:0xf bound_ctrl:0
  s_nop 1
  v_add_u32_dpp v37, v37, v37 row_shr:2 row_mask:0xf bank_mask:0xf bound_ctrl:0
  s_nop 1
  v_add_u32_dpp v37, v37, v37 row_shr:4 row_mask:0xf bank_mask:0xf bound_ctrl:0
  s_nop 1
  v_add_u32_dpp v37, v37, v37 row_shr:8 row_mask:0xf bank_mask:0xf bound_ctrl:0
  s_nop 1
  v_add_u32_dpp v37, v37, v37 row_bcast:15 row_mask:0xa bank_mask:0xf
  s_nop 1
  v_add_u32_dpp v37, v37, v37 row_bcast:31 row_mask:0xc bank_mask:0xf
  v_lshl_add_u32 v45, v37, 4, v44
  ds_write_b32 v40, v45 offset:3424
  ds_read_b32 v16, v20 offset:3424
  ds_read_b32 v17, v21 offset:3424
  ds_read_b32 v18, v22 offset:3424
  v_sub_u32 v36, v36, v39
  v_readlane_b32 s9, v37, 63
  v_cndmask_b32 v36, v36, v45, s[12:13]
  s_cmp_lg_u32 s11, 0
  s_cselect_b32 s9, 0x7fff, s9
  v_mov_b32 v46, s9
  s_waitcnt lgkmcnt(4)
  ds_write_b32 v6, v36 offset:2816
  ds_write_b32 v6, v38 offset:3824
  s_mov_b64 exec, 1
  ds_write_b32 v3, v46 offset:16204
  s_mov_b64 exec, -1
  s_waitcnt lgkmcnt(5)
  v_lshl_add_u32 v27, v12, 2, v16
  v_lshl_add_u32 v24, v25, 4, v27
  v_lshl_add_u32 v25, v26, 4, v27
  v_lshl_add_u32 v26, v48, 4, v27
  ds_write_b128 v5, v[24:27] offset:0
  s_waitcnt lgkmcnt(5)
  v_lshl_add_u32 v31, v13, 2, v17
  v_lshl_add_u32 v28, v29, 4, v31
  v_lshl_add_u32 v29, v30, 4, v31
  v_lshl_add_u32 v30, v49, 4, v31
  ds_write_b128 v5, v[28:31] offset:1024
  s_waitcnt lgkmcnt(5)
  v_lshl_add_u32 v35, v14, 2, v18
  v_lshl_add_u32 v32, v33, 4, v35
  v_lshl_add_u32 v33, v34, 4, v35
  v_lshl_add_u32 v34, v50, 4, v35
  s_mov_b32 exec_hi, 0
  ds_write_b128 v5, v[32:35] offset:2048
  s_mov_b64 exec, 1
  ds_write_b32 v3, v46 offset:16180
  s_mov_b64 exec, -1
  s_setprio 0
K_PAR:
  v_lshrrev_b32 v24, 4, v1
  v_and_b32 v25, 15, v1
  v_lshlrev_b32 v13, 4, v25
  s_lshl_b32 s8, s3, 4
  v_add_u32 v26, s8, v24
  v_mov_b32 v27, s8
  v_lshl_add_u32 v38, v24, 2, v13
  s_mov_b32 s80, 0x400000
K_PMW:
  ds_read_b32 v4, v3 offset:16204
  ds_read_b128 v[28:31], v27 offset:2816
  ds_read_u8 v8, v26 offset:3828
  ds_read_u8 v9, v26 offset:3832
  ds_read_u8 v10, v26 offset:3836
  ds_read_b32 v37, v38 offset:2560
  v_mov_b32 v15, v13
  v_mov_b32 v17, v13
  v_mov_b32 v19, v13
  v_mov_b32 v62, 16128
  s_waitcnt lgkmcnt(4)
  v_readfirstlane_b32 s8, v4
  v_readfirstlane_b32 s20, v28
  s_cmp_lg_u32 s8, 0
  s_cbranch_scc1 K_PMD
  s_sleep 4
  s_sub_u32 s80, s80, 1
  s_cbranch_scc0 K_PMW
K_PMD:
  v_lshl_add_u32 v38, v24, 2, s20
  s_lshl_b32 s9, s4, 7
  v_lshl_add_u32 v32, v25, 3, s9
  v_add_u32 v33, 99280, v13
  v_mov_b32 v34, 142720
  v_bfrev_b32 v35, 2
  s_mul_i32 s31, s5, 157
  s_sub_u32 s31, 10000, s31
  s_min_u32 s31, s31, 157
  s_movk_i32 s10, 272
  s_movk_i32 s11, 0x7f
  v_mov_b32 v39, 3600
  v_mov_b64 v[40:41], 64
  s_mov_b32 exec_lo, 0x22221111
  s_mov_b32 exec_hi, 0x88884444
  v_and_b32 v39, 12, v1
  v_add_u32 v39, s20, v39
  v_mov_b32 v41, 64
  s_mov_b64 exec, -1
  s_waitcnt lgkmcnt(3)
  v_lshlrev_b32 v2, 4, v8
  v_and_b32 v2, 0xf0, v2
  v_xor_b32 v2, v2, v32
  v_lshl_add_u32 v4, v8, 9, v2
  ds_read_b64 v[56:57], v4 offset:16384
  v_and_or_b32 v2, v2, s11, v34
  v_cmp_gt_u32 vcc, s31, v8
  v_lshl_add_u32 v0, v8, 7, v2
  v_lshl_add_u32 v20, v8, 9, v32
  v_mad_u32_u24 v8, v8, s10, v33
  v_cndmask_b32 v20, v35, v20, vcc
  s_waitcnt lgkmcnt(3)
  v_lshlrev_b32 v2, 4, v9
  v_and_b32 v2, 0xf0, v2
  v_xor_b32 v2, v2, v32
  v_lshl_add_u32 v4, v9, 9, v2
  ds_read_b64 v[58:59], v4 offset:16384
  v_and_or_b32 v2, v2, s11, v34
  v_cmp_gt_u32 vcc, s31, v9
  v_lshl_add_u32 v23, v9, 7, v2
  v_lshl_add_u32 v21, v9, 9, v32
  v_lshl_add_u32 v42, v9, 9, v13
  v_mad_u32_u24 v9, v9, s10, v33
  v_cndmask_b32 v21, v35, v21, vcc
  s_waitcnt lgkmcnt(3)
  v_lshlrev_b32 v2, 4, v10
  v_and_b32 v2, 0xf0, v2
  v_xor_b32 v2, v2, v32
  v_lshl_add_u32 v4, v10, 9, v2
  ds_read_b64 v[60:61], v4 offset:16384
  v_and_or_b32 v2, v2, s11, v34
  v_cmp_gt_u32 vcc, s31, v10
  v_lshl_add_u32 v63, v10, 7, v2
  v_lshl_add_u32 v22, v10, 9, v32
  v_lshl_add_u32 v43, v10, 9, v13
  v_mad_u32_u24 v10, v10, s10, v33
  v_cndmask_b32 v22, v35, v22, vcc
  v_readfirstlane_b32 s21, v29
  v_readfirstlane_b32 s22, v30
  v_readfirstlane_b32 s23, v31
  s_waitcnt lgkmcnt(3)
  v_cvt_pk_bf16_f32 v36, v3, v37
  v_mov_b32 v37, 0
  v_mov_b32 v5, v13
  v_mov_b32 v7, v13
  v_mov_b32 v88, -1
  v_mov_b32 v90, 0
  v_mov_b64 v[24:25], s[76:77]
  v_mov_b64 v[26:27], s[76:77]
  v_mov_b64 v[28:29], 0
  v_mov_b64 v[30:31], 0
  s_add_u32 s27, s21, s22
  s_add_u32 s27, s27, s23
  s_mul_i32 s27, s27, 0x01010101
  s_lshr_b32 s13, s27, 24
  s_sub_i32 s27, s13, 22
  s_max_i32 s27, s27, 0
  s_lshr_b32 s27, s27, 2
  s_mov_b32 s29, 0
  s_mov_b32 s30, 3
  s_mov_b32 s46, 0
  s_mov_b32 s32, 1048576000
  s_mov_b32 s33, s32
  s_ff1_i32_b32 s25, s21
  s_and_b32 s25, s25, 24
  s_lshr_b32 s26, s21, s25
  s_and_b32 s26, s26, 0xff
  s_lshl_b32 s28, s26, s25
  s_sub_u32 s24, s21, s28
  s_sub_u32 s26, s26, 1
  s_waitcnt lgkmcnt(2)
  v_lshlrev_b32 v44, 16, v56
  v_and_b32 v45, s78, v56
  v_lshlrev_b32 v46, 16, v57
  v_and_b32 v47, s78, v57
  v_pk_fma_f16 v90, v56, 0, v90
  v_pk_fma_f16 v90, v57, 0, v90
  s_waitcnt lgkmcnt(1)
  v_lshlrev_b32 v48, 16, v58
  v_and_b32 v49, s78, v58
  v_lshlrev_b32 v50, 16, v59
  v_and_b32 v51, s78, v59
  v_pk_fma_f16 v90, v58, 0, v90
  v_pk_fma_f16 v90, v59, 0, v90
  s_cmp_eq_u32 s23, 0
  s_cbranch_scc1 K_NB
  s_waitcnt lgkmcnt(0)
  v_lshlrev_b32 v52, 16, v60
  v_and_b32 v53, s78, v60
  v_lshlrev_b32 v54, 16, v61
  v_and_b32 v55, s78, v61
  v_pk_fma_f16 v90, v60, 0, v90
  v_pk_fma_f16 v90, v61, 0, v90
K_NB:
  s_cmp_lg_u32 s3, 13
  s_cbranch_scc1 K_NPT
  s_setprio 3
  s_mov_b32 s80, 0x400000
K_TW13:
  ds_read_b32 v4, v3 offset:16176
  s_waitcnt lgkmcnt(0)
  v_readfirstlane_b32 s8, v4
  s_cmp_eq_u32 s8, 4
  s_cbranch_scc1 K_TW13_D
  s_sleep 2
  s_sub_u32 s80, s80, 1
  s_cbranch_scc0 K_TW13
K_TW13_D:
  ds_read_b32 v4, v3 offset:16172
  v_lshlrev_b32 v93, 7, v1
  s_mov_b32 s8, 65536
  s_waitcnt lgkmcnt(0)
K_PT_L:
  buffer_load_dword v92, v93, s[52:55], s59 offen sc1
  s_sub_u32 s8, s8, 1
  s_waitcnt vmcnt(0)
  s_cbranch_scc1 K_PT_D
  v_cmpx_ne_u32 vcc, v4, v92
  s_cbranch_execnz K_PT_L
K_PT_D:
  s_cselect_b32 s8, 0x10010, 16
  s_mov_b64 exec, 1
  v_mov_b32 v2, s8
  ds_add_u32 v3, v2 offset:16224
  s_mov_b64 exec, -1
K_NPT:
  s_setprio 0
  s_mov_b32 s80, 0x400000
K_R1:
  ds_read_b32 v125, v62 offset:96
  s_waitcnt lgkmcnt(0)
  v_readfirstlane_b32 s8, v125
  s_bitcmp1_b32 s8, 2
  s_cbranch_scc1 K_R1_D
  s_sleep 1
  s_sub_u32 s80, s80, 1
  s_cbranch_scc0 K_R1
K_R1_D:
  ds_read_u16 v12, v38 offset:0
  ds_read_u16 v14, v38 offset:16
  ds_read_u16 v16, v38 offset:32
  ds_read_u16 v18, v38 offset:48
  ds_read_u16 v4, v38 offset:64
  ds_read2_b32 v[2:3], v39 offset0:0 offset1:4
  ds_read_u16 v6, v38 offset:80
  s_mov_b32 s80, 0x400000
K_R2:
  ds_read_b32 v125, v62 offset:96
  s_waitcnt lgkmcnt(0)
  v_readfirstlane_b32 s8, v125
  s_and_b32 s9, s8, 0x810
  s_cbranch_scc1 K_R2_D
  s_sleep 1
  s_sub_u32 s80, s80, 1
  s_cbranch_scc0 K_R2
K_R2_D:
  s_setprio 3
  s_and_b32 s15, s8, 16
  s_cbranch_scc0 K_R3_D
  buffer_load_dwordx4 v[96:99], v[12:13], s[60:63], 0 idxen offen sc1
  buffer_load_dwordx4 v[100:103], v[14:15], s[60:63], 0 idxen offen sc1
  buffer_load_dwordx4 v[104:107], v[16:17], s[60:63], 0 idxen offen sc1
  buffer_load_dwordx4 v[108:111], v[18:19], s[60:63], 0 idxen offen sc1
  s_bitcmp1_b32 s8, 11
  s_cbranch_scc1 K_R3_D
  s_setprio 0
  s_mov_b32 s80, 0x400000
K_R3:
  ds_read_b32 v125, v62 offset:96
  s_waitcnt lgkmcnt(0)
  v_readfirstlane_b32 s8, v125
  s_bitcmp1_b32 s8, 11
  s_cbranch_scc1 K_R3_D
  s_sleep 1
  s_sub_u32 s80, s80, 1
  s_cbranch_scc0 K_R3
K_R3_D:
  s_setprio 3
  ds_read_b128 v[112:115], v8
  ds_read_b64 v[72:73], v0 offset:80
  ds_read_b128 v[116:119], v9
  ds_read_b64 v[74:75], v23 offset:80
  ds_read_b128 v[120:123], v10
  ds_read_b64 v[76:77], v63 offset:80
  s_waitcnt lgkmcnt(5)
  v_exp_f32_e64 v32, v112 clamp
  v_exp_f32_e64 v33, v113 clamp
  v_exp_f32_e64 v34, v114 clamp
  v_exp_f32_e64 v35, v115 clamp
  v_exp_f32_e64 v112, -v112 clamp
  v_exp_f32_e64 v113, -v113 clamp
  v_exp_f32_e64 v114, -v114 clamp
  v_exp_f32_e64 v115, -v115 clamp
  v_min3_u32 v88, v88, v32, v33
  v_min3_u32 v88, v88, v34, v35
  v_pk_mul_f32 v[84:85], v[112:113], s[32:33]
  v_pk_mul_f32 v[86:87], v[114:115], s[32:33]
  v_pk_mul_f32 v[80:81], v[112:113], s[32:33]
  v_pk_mul_f32 v[82:83], v[114:115], s[32:33]
  s_waitcnt lgkmcnt(4)
  v_lshlrev_b32 v92, 16, v72
  v_and_b32 v93, s78, v72
  v_lshlrev_b32 v94, 16, v73
  v_and_b32 v95, s78, v73
  v_pk_add_f32 v[44:45], v[44:45], v[92:93]
  v_pk_add_f32 v[46:47], v[46:47], v[94:95]
  s_waitcnt lgkmcnt(3)
  v_exp_f32_e64 v64, v116 clamp
  v_exp_f32_e64 v65, v117 clamp
  v_exp_f32_e64 v66, v118 clamp
  v_exp_f32_e64 v67, v119 clamp
  v_exp_f32_e64 v116, -v116 clamp
  v_exp_f32_e64 v117, -v117 clamp
  v_exp_f32_e64 v118, -v118 clamp
  v_exp_f32_e64 v119, -v119 clamp
  ds_write_b128 v42, v[64:67] offset:16640
  v_min3_u32 v88, v88, v64, v65
  v_min3_u32 v88, v88, v66, v67
  v_pk_mul_f32 v[116:117], v[116:117], s[32:33]
  v_pk_mul_f32 v[118:119], v[118:119], s[32:33]
  ds_write_b128 v42, v[116:119] offset:16384
  s_waitcnt lgkmcnt(4)
  v_lshlrev_b32 v92, 16, v74
  v_and_b32 v93, s78, v74
  v_lshlrev_b32 v94, 16, v75
  v_and_b32 v95, s78, v75
  v_pk_add_f32 v[48:49], v[48:49], v[92:93]
  v_pk_add_f32 v[50:51], v[50:51], v[94:95]
  s_cmp_eq_u32 s23, 0
  s_cbranch_scc1 K_PQ
  s_waitcnt lgkmcnt(3)
  v_exp_f32_e64 v68, v120 clamp
  v_exp_f32_e64 v69, v121 clamp
  v_exp_f32_e64 v70, v122 clamp
  v_exp_f32_e64 v71, v123 clamp
  v_exp_f32_e64 v120, -v120 clamp
  v_exp_f32_e64 v121, -v121 clamp
  v_exp_f32_e64 v122, -v122 clamp
  v_exp_f32_e64 v123, -v123 clamp
  ds_write_b128 v43, v[68:71] offset:16640
  v_min3_u32 v88, v88, v68, v69
  v_min3_u32 v88, v88, v70, v71
  v_pk_mul_f32 v[120:121], v[120:121], s[32:33]
  v_pk_mul_f32 v[122:123], v[122:123], s[32:33]
  ds_write_b128 v43, v[120:123] offset:16384
  s_waitcnt lgkmcnt(4)
  v_lshlrev_b32 v92, 16, v76
  v_and_b32 v93, s78, v76
  v_lshlrev_b32 v94, 16, v77
  v_and_b32 v95, s78, v77
  v_pk_add_f32 v[52:53], v[52:53], v[92:93]
  v_pk_add_f32 v[54:55], v[54:55], v[94:95]
K_PQ:
  s_cmp_lg_u32 s15, 0
  s_cbranch_scc1 K_RG
  s_mov_b32 s80, 0x400000
K_R4:
  ds_read_b32 v125, v62 offset:96
  s_waitcnt lgkmcnt(0)
  v_readfirstlane_b32 s8, v125
  s_bitcmp1_b32 s8, 4
  s_cbranch_scc1 K_R4_D
  s_sleep 1
  s_sub_u32 s80, s80, 1
  s_cbranch_scc0 K_R4
K_R4_D:
  buffer_load_dwordx4 v[96:99], v[12:13], s[60:63], 0 idxen offen sc1
  buffer_load_dwordx4 v[100:103], v[14:15], s[60:63], 0 idxen offen sc1
  buffer_load_dwordx4 v[104:107], v[16:17], s[60:63], 0 idxen offen sc1
  buffer_load_dwordx4 v[108:111], v[18:19], s[60:63], 0 idxen offen sc1
K_RG:
  s_cmp_gt_u32 s8, 0xffff
  s_cbranch_scc1 K_SLOW
  s_setprio 3
  v_mov_b32 v16, 0
  v_mov_b32 v17, v36
  s_waitcnt lgkmcnt(0)
  s_waitcnt vmcnt(3) lgkmcnt(1)
  v_lshlrev_b64 v[72:73], 16, v[96:97]
  v_mfma_f32_16x16x16_bf16 v[64:67], v[2:3], v[36:37], v[96:99]
  v_lshlrev_b64 v[74:75], 16, v[98:99]
  buffer_load_dwordx4 v[96:99], v[4:5], s[60:63], 0 idxen offen sc1
  ds_read_u16 v4, v38 offset:96
  ds_read2_b32 v[126:127], v39 offset0:8 offset1:12
  s_nop 2
.p2align 6
K_LOOP:
  s_waitcnt vmcnt(3) lgkmcnt(2)
  v_exp_f32 v64, v64
  v_lshlrev_b64 v[76:77], 16, v[100:101]
  v_mfma_f32_16x16x16_bf16 v[68:71], v[2:3], v[16:17], v[100:103]
  v_exp_f32 v65, v65
  v_exp_f32 v66, v66
  v_lshlrev_b64 v[78:79], 16, v[102:103]
  v_exp_f32 v67, v67
  buffer_load_dwordx4 v[100:103], v[6:7], s[60:63], 0 idxen offen sc1
  ds_read_u16 v6, v38 offset:112
  v_pk_mul_f32 v[72:73], v[72:73], v[80:81]
  v_pk_mul_f32 v[74:75], v[74:75], v[82:83]
  v_pk_fma_f32 v[64:65], v[32:33], v[64:65], v[84:85]
  v_pk_fma_f32 v[66:67], v[34:35], v[66:67], v[86:87]
  v_pk_fma_f32 v[24:25], v[24:25], v[64:65], v[80:81]
  v_pk_fma_f32 v[26:27], v[26:27], v[66:67], v[82:83]
  v_pk_fma_f32 v[28:29], v[28:29], v[64:65], v[72:73]
  v_pk_fma_f32 v[30:31], v[30:31], v[66:67], v[74:75]
  s_sub_u32 s26, s26, 1
  v_pk_mul_f32 v[80:81], v[80:81], v[64:65]
  v_pk_mul_f32 v[82:83], v[82:83], v[66:67]
  s_cbranch_scc1 K_EV0
K_RV0:
  s_waitcnt vmcnt(3) lgkmcnt(1)
  v_exp_f32 v68, v68
  v_lshlrev_b64 v[72:73], 16, v[104:105]
  v_mfma_f32_16x16x16_bf16 v[64:67], v[126:127], v[36:37], v[104:107]
  v_exp_f32 v69, v69
  v_exp_f32 v70, v70
  v_lshlrev_b64 v[74:75], 16, v[106:107]
  v_exp_f32 v71, v71
  buffer_load_dwordx4 v[104:107], v[4:5], s[60:63], 0 idxen offen sc1
  ds_read_u16 v4, v38 offset:128
  ds_read2_b32 v[2:3], v39 offset0:16 offset1:20
  v_pk_mul_f32 v[76:77], v[76:77], v[80:81]
  v_pk_mul_f32 v[78:79], v[78:79], v[82:83]
  v_pk_fma_f32 v[68:69], v[32:33], v[68:69], v[84:85]
  v_pk_fma_f32 v[70:71], v[34:35], v[70:71], v[86:87]
  v_pk_fma_f32 v[24:25], v[24:25], v[68:69], v[80:81]
  v_pk_fma_f32 v[26:27], v[26:27], v[70:71], v[82:83]
  v_pk_fma_f32 v[28:29], v[28:29], v[68:69], v[76:77]
  v_pk_fma_f32 v[30:31], v[30:31], v[70:71], v[78:79]
  s_sub_u32 s26, s26, 1
  v_pk_mul_f32 v[80:81], v[80:81], v[68:69]
  v_pk_mul_f32 v[82:83], v[82:83], v[70:71]
  s_cbranch_scc1 K_EV1
K_RV1:
  s_waitcnt vmcnt(3) lgkmcnt(2)
  v_exp_f32 v64, v64
  v_lshlrev_b64 v[76:77], 16, v[108:109]
  v_mfma_f32_16x16x16_bf16 v[68:71], v[126:127], v[16:17], v[108:111]
  v_exp_f32 v65, v65
  v_exp_f32 v66, v66
  v_lshlrev_b64 v[78:79], 16, v[110:111]
  v_exp_f32 v67, v67
  buffer_load_dwordx4 v[108:111], v[6:7], s[60:63], 0 idxen offen sc1
  ds_read_u16 v6, v38 offset:144
  v_pk_mul_f32 v[72:73], v[72:73], v[80:81]
  v_pk_mul_f32 v[74:75], v[74:75], v[82:83]
  v_pk_fma_f32 v[64:65], v[32:33], v[64:65], v[84:85]
  v_pk_fma_f32 v[66:67], v[34:35], v[66:67], v[86:87]
  v_pk_fma_f32 v[24:25], v[24:25], v[64:65], v[80:81]
  v_pk_fma_f32 v[26:27], v[26:27], v[66:67], v[82:83]
  v_pk_fma_f32 v[28:29], v[28:29], v[64:65], v[72:73]
  v_pk_fma_f32 v[30:31], v[30:31], v[66:67], v[74:75]
  s_sub_u32 s26, s26, 1
  v_pk_mul_f32 v[80:81], v[80:81], v[64:65]
  v_pk_mul_f32 v[82:83], v[82:83], v[66:67]
  s_cbranch_scc1 K_EV2
K_RV2:
  s_waitcnt vmcnt(3) lgkmcnt(1)
  v_exp_f32 v68, v68
  v_lshlrev_b64 v[72:73], 16, v[96:97]
  v_mfma_f32_16x16x16_bf16 v[64:67], v[2:3], v[36:37], v[96:99]
  v_exp_f32 v69, v69
  v_exp_f32 v70, v70
  v_lshlrev_b64 v[74:75], 16, v[98:99]
  v_exp_f32 v71, v71
  buffer_load_dwordx4 v[96:99], v[4:5], s[60:63], 0 idxen offen sc1
  ds_read_u16 v4, v38 offset:160
  ds_read2_b32 v[126:127], v39 offset0:24 offset1:28
  v_pk_mul_f32 v[76:77], v[76:77], v[80:81]
  v_pk_mul_f32 v[78:79], v[78:79], v[82:83]
  v_pk_fma_f32 v[68:69], v[32:33], v[68:69], v[84:85]
  v_pk_fma_f32 v[70:71], v[34:35], v[70:71], v[86:87]
  v_pk_fma_f32 v[24:25], v[24:25], v[68:69], v[80:81]
  v_pk_fma_f32 v[26:27], v[26:27], v[70:71], v[82:83]
  v_pk_fma_f32 v[28:29], v[28:29], v[68:69], v[76:77]
  v_pk_fma_f32 v[30:31], v[30:31], v[70:71], v[78:79]
  s_sub_u32 s26, s26, 1
  v_pk_mul_f32 v[80:81], v[80:81], v[68:69]
  v_pk_mul_f32 v[82:83], v[82:83], v[70:71]
  s_cbranch_scc1 K_EV3
K_RV3:
  s_sub_u32 s27, s27, 1
  v_lshl_add_u64 v[38:39], v[38:39], 0, v[40:41]
  s_cbranch_scc0 K_LOOP
  s_sub_u32 s30, s30, 1
  s_cmp_eq_u32 s30, 2
  s_cbranch_scc1 K_P2
  s_cmp_eq_u32 s30, 1
  s_cbranch_scc1 K_P1
  s_setprio 0
  s_mov_b32 s62, 0
  s_movk_i32 s27, 0x7fff
  s_branch K_LOOP
K_P3:
  s_setprio 3
  s_mov_b32 s27, s34
  s_branch K_LOOP
K_P2:
  s_setprio 2
  s_mov_b32 s27, 2
  s_branch K_LOOP
K_P1:
  s_setprio 1
  s_mov_b32 s27, 0
  s_branch K_LOOP
K_EV0:
  s_call_b64 s[44:45], K_EV
  s_branch K_RV0
K_EV1:
  s_call_b64 s[44:45], K_EV
  s_branch K_RV1
K_EV2:
  s_call_b64 s[44:45], K_EV
  s_branch K_RV2
K_EV3:
  s_call_b64 s[44:45], K_EV
  s_branch K_RV3
K_EV:
  s_cmp_eq_u32 s25, 24
  s_cbranch_scc1 K_FN
  s_lshl1_add_u32 s28, s25, 16
  s_lshl_b64 exec, -1, s28
  v_mov_b64 v[80:81], v[84:85]
  v_mov_b64 v[82:83], v[86:87]
  v_mov_b64 v[24:25], s[76:77]
  v_mov_b64 v[26:27], s[76:77]
  s_mov_b64 exec, -1
K_NXT:
  s_ff1_i32_b32 s25, s24
  s_and_b32 s25, s25, 24
  s_lshr_b32 s26, s24, s25
  s_and_b32 s26, s26, 0xff
  s_lshl_b32 s28, s26, s25
  s_sub_u32 s24, s24, s28
  s_sub_u32 s26, s26, 1
  s_waitcnt lgkmcnt(0)
  s_setpc_b64 s[44:45]
K_FN:
  s_add_u32 s29, s29, 1
  s_cmp_eq_u32 s29, 2
  s_cbranch_scc1 K_F1
  s_cmp_eq_u32 s29, 3
  s_cbranch_scc1 K_F2
  ds_read_b128 v[84:87], v42 offset:16384
  ds_read_b128 v[32:35], v42 offset:16640
  v_pk_mul_f32 v[92:93], v[24:25], s[74:75]
  v_pk_mul_f32 v[94:95], v[26:27], s[74:75]
  ds_read_b128 v[24:27], v62 offset:80
  v_min3_u32 v88, v88, v80, v81
  v_min3_u32 v88, v88, v82, v83
  ds_read_b128 v[80:83], v42 offset:16384
  v_rcp_f32 v92, v92
  v_rcp_f32 v93, v93
  v_rcp_f32 v94, v94
  v_rcp_f32 v95, v95
  v_pk_fma_f32 v[44:45], v[28:29], v[92:93], v[44:45]
  v_pk_fma_f32 v[46:47], v[30:31], v[94:95], v[46:47]
  ds_read_b128 v[28:31], v62 offset:0
  v_cvt_pk_bf16_f32 v44, v44, v45
  v_cvt_pk_bf16_f32 v45, v46, v47
  v_pk_max_f16 v46, v44, v56
  v_pk_max_f16 v47, v45, v57
  buffer_store_dwordx2 v[46:47], v20, s[64:67], s6 offen sc1
  v_min3_u32 v88, v88, v92, v93
  v_min3_u32 v88, v88, v94, v95
  v_pk_fma_f16 v90, v44, 0, v90
  v_pk_fma_f16 v90, v45, 0, v90
  s_mov_b32 s24, s22
  s_branch K_NXT
K_F1:
  s_cmp_eq_u32 s23, 0
  s_cbranch_scc1 K_F1L
  ds_read_b128 v[84:87], v43 offset:16384
  ds_read_b128 v[32:35], v43 offset:16640
  v_pk_mul_f32 v[92:93], v[24:25], s[74:75]
  v_pk_mul_f32 v[94:95], v[26:27], s[74:75]
  ds_read_b128 v[24:27], v62 offset:80
  v_min3_u32 v88, v88, v80, v81
  v_min3_u32 v88, v88, v82, v83
  ds_read_b128 v[80:83], v43 offset:16384
  v_rcp_f32 v92, v92
  v_rcp_f32 v93, v93
  v_rcp_f32 v94, v94
  v_rcp_f32 v95, v95
  v_pk_fma_f32 v[48:49], v[28:29], v[92:93], v[48:49]
  v_pk_fma_f32 v[50:51], v[30:31], v[94:95], v[50:51]
  ds_read_b128 v[28:31], v62 offset:0
  v_cvt_pk_bf16_f32 v48, v48, v49
  v_cvt_pk_bf16_f32 v49, v50, v51
  v_pk_max_f16 v50, v48, v58
  v_pk_max_f16 v51, v49, v59
  buffer_store_dwordx2 v[50:51], v21, s[64:67], s6 offen sc1
  v_min3_u32 v88, v88, v92, v93
  v_min3_u32 v88, v88, v94, v95
  v_pk_fma_f16 v90, v48, 0, v90
  v_pk_fma_f16 v90, v49, 0, v90
  s_mov_b32 s24, s23
  s_branch K_NXT
K_F1L:
  s_setprio 3
  v_pk_mul_f32 v[92:93], v[24:25], s[74:75]
  v_pk_mul_f32 v[94:95], v[26:27], s[74:75]
  v_rcp_f32 v92, v92
  v_rcp_f32 v93, v93
  v_rcp_f32 v94, v94
  v_rcp_f32 v95, v95
  v_pk_fma_f32 v[48:49], v[28:29], v[92:93], v[48:49]
  v_pk_fma_f32 v[50:51], v[30:31], v[94:95], v[50:51]
  v_cvt_pk_bf16_f32 v48, v48, v49
  v_cvt_pk_bf16_f32 v49, v50, v51
  v_pk_max_f16 v50, v48, v58
  v_pk_max_f16 v51, v49, v59
  buffer_store_dwordx2 v[50:51], v21, s[64:67], s6 offen sc1
  v_min3_u32 v88, v88, v92, v93
  v_min3_u32 v88, v88, v94, v95
  v_pk_fma_f16 v90, v48, 0, v90
  v_pk_fma_f16 v90, v49, 0, v90
  v_min3_u32 v88, v88, v80, v81
  v_min3_u32 v88, v88, v82, v83
  s_branch K_CK
K_F2:
  s_setprio 3
  v_pk_mul_f32 v[92:93], v[24:25], s[74:75]
  v_pk_mul_f32 v[94:95], v[26:27], s[74:75]
  v_rcp_f32 v92, v92
  v_rcp_f32 v93, v93
  v_rcp_f32 v94, v94
  v_rcp_f32 v95, v95
  v_pk_fma_f32 v[52:53], v[28:29], v[92:93], v[52:53]
  v_pk_fma_f32 v[54:55], v[30:31], v[94:95], v[54:55]
  v_cvt_pk_bf16_f32 v52, v52, v53
  v_cvt_pk_bf16_f32 v53, v54, v55
  v_pk_max_f16 v54, v52, v60
  v_pk_max_f16 v55, v53, v61
  buffer_store_dwordx2 v[54:55], v22, s[64:67], s6 offen sc1
  v_min3_u32 v88, v88, v92, v93
  v_min3_u32 v88, v88, v94, v95
  v_pk_fma_f16 v90, v52, 0, v90
  v_pk_fma_f16 v90, v53, 0, v90
  v_min3_u32 v88, v88, v80, v81
  v_min3_u32 v88, v88, v82, v83
K_CK:
  v_cmp_eq_u32 vcc, 0, v88
  v_and_b32 v90, 0x7fff7fff, v90
  v_cmp_ne_u32 s[8:9], 0, v90
  s_or_b64 vcc, vcc, s[8:9]
  s_cselect_b32 s8, 1, s46
  s_cmp_lg_u32 s8, 0
  s_cbranch_scc1 K_REDO
K_DONE:
K_END:
  s_endpgm
K_REDO:
  ds_read_b128 v[64:67], v5 offset:2560
  v_lshrrev_b32 v38, 4, v1
  v_lshl_add_u32 v38, v38, 2, s20
  s_movk_i32 s11, 10240
  s_mov_b32 s62, s11
  s_waitcnt vmcnt(0)
K_RR:
  ds_read_b128 v[84:87], v8
  ds_read_b64 v[72:73], v0 offset:80
  s_mul_i32 s10, s21, 0x01010101
  s_lshr_b32 s10, s10, 24
  v_mov_b64 v[24:25], s[76:77]
  v_mov_b64 v[26:27], s[76:77]
  v_mov_b64 v[28:29], 0
  v_mov_b64 v[30:31], 0
  s_waitcnt lgkmcnt(0)
  v_add_f32 v84, 0x40000000, v84
  v_add_f32 v85, 0x40000000, v85
  v_add_f32 v86, 0x40000000, v86
  v_add_f32 v87, 0x40000000, v87
K_RE:
  ds_read_b32 v2, v38
  v_add_u32 v38, 16, v38
  s_waitcnt lgkmcnt(0)
  v_and_b32 v4, 0xffff, v2
  v_and_b32 v2, s78, v2
  buffer_load_dwordx4 v[96:99], v[4:5], s[60:63], 0 idxen offen sc1
  v_cmpx_ne_u32 vcc, s11, v4
  s_waitcnt vmcnt(0)
  v_fma_f32 v68, v2, v64, v84
  v_fma_f32 v69, v2, v65, v85
  v_fma_f32 v70, v2, v66, v86
  v_fma_f32 v71, v2, v67, v87
  v_add_f32 v68, v68, v96
  v_add_f32 v69, v69, v97
  v_add_f32 v70, v70, v98
  v_add_f32 v71, v71, v99
  v_exp_f32 v68, v68
  v_exp_f32 v69, v69
  v_exp_f32 v70, v70
  v_exp_f32 v71, v71
  v_lshlrev_b64 v[96:97], 16, v[96:97]
  v_lshlrev_b64 v[98:99], 16, v[98:99]
  v_add_f32 v68, 1.0, v68
  v_add_f32 v69, 1.0, v69
  v_add_f32 v70, 1.0, v70
  v_add_f32 v71, 1.0, v71
  v_rcp_f32 v68, v68
  v_rcp_f32 v69, v69
  v_rcp_f32 v70, v70
  v_rcp_f32 v71, v71
  v_mul_f32 v96, 0x37800000, v96
  v_mul_f32 v97, 0x37800000, v97
  v_mul_f32 v98, 0x37800000, v98
  v_mul_f32 v99, 0x37800000, v99
  v_add_f32 v24, v24, v68
  v_fma_f32 v28, v96, v68, v28
  v_add_f32 v25, v25, v69
  v_fma_f32 v29, v97, v69, v29
  v_add_f32 v26, v26, v70
  v_fma_f32 v30, v98, v70, v30
  v_add_f32 v27, v27, v71
  v_fma_f32 v31, v99, v71, v31
  s_mov_b64 exec, -1
  s_sub_u32 s10, s10, 1
  s_cmp_lg_u32 s10, 0
  s_cbranch_scc1 K_RE
  v_lshlrev_b32 v76, 16, v72
  v_and_b32 v77, s78, v72
  v_lshlrev_b32 v78, 16, v73
  v_and_b32 v79, s78, v73
  v_lshlrev_b32 v80, 16, v56
  v_and_b32 v81, s78, v56
  v_lshlrev_b32 v82, 16, v57
  v_and_b32 v83, s78, v57
  v_rcp_f32 v24, v24
  v_rcp_f32 v25, v25
  v_rcp_f32 v26, v26
  v_rcp_f32 v27, v27
  v_fma_f32 v28, v28, v24, v76
  v_fma_f32 v29, v29, v25, v77
  v_fma_f32 v30, v30, v26, v78
  v_fma_f32 v31, v31, v27, v79
  v_cmp_nle_f32 vcc, v28, 0
  s_nop 1
  v_cndmask_b32 v28, 0, v28, vcc
  v_add_f32 v28, v28, v80
  v_cmp_nle_f32 vcc, v29, 0
  s_nop 1
  v_cndmask_b32 v29, 0, v29, vcc
  v_add_f32 v29, v29, v81
  v_cmp_nle_f32 vcc, v30, 0
  s_nop 1
  v_cndmask_b32 v30, 0, v30, vcc
  v_add_f32 v30, v30, v82
  v_cmp_nle_f32 vcc, v31, 0
  s_nop 1
  v_cndmask_b32 v31, 0, v31, vcc
  v_add_f32 v31, v31, v83
  v_cvt_pk_bf16_f32 v28, v28, v29
  v_cvt_pk_bf16_f32 v29, v30, v31
  buffer_store_dwordx2 v[28:29], v20, s[64:67], s6 offen sc1
  v_mov_b32 v8, v9
  v_mov_b32 v0, v23
  v_mov_b64 v[56:57], v[58:59]
  v_mov_b32 v9, v10
  v_mov_b32 v23, v63
  v_mov_b64 v[58:59], v[60:61]
  s_waitcnt vmcnt(0)
  v_mov_b32 v20, v21
  v_mov_b32 v21, v22
  s_mov_b32 s21, s22
  s_mov_b32 s22, s23
  s_mov_b32 s23, 0
  s_cmp_lg_u32 s21, 0
  s_cbranch_scc1 K_RR
  s_branch K_DONE
K_FIN0:
  s_mov_b64 exec, -1
  s_waitcnt lgkmcnt(0)
  s_barrier
  ds_read_b128 v[64:67], v59 offset:16384
  ds_read_b128 v[68:71], v59 offset:16400
  ds_read_b128 v[72:75], v59 offset:16640
  ds_read_b128 v[76:79], v59 offset:16656
  v_add_u32 v59, 67584, v59
  s_cmp_lt_u32 s3, 4
  s_cselect_b64 exec, -1, 1
  ds_read_b128 v[80:83], v59 offset:16384
  ds_read_b128 v[84:87], v59 offset:16400
  ds_read_b128 v[88:91], v59 offset:16640
  ds_read_b128 v[92:95], v59 offset:16656
  s_mov_b64 exec, -1
  s_waitcnt lgkmcnt(6)
  v_pk_add_f32 v[64:65], v[64:65], s[76:77]
  v_pk_add_f32 v[66:67], v[66:67], s[76:77]
  v_pk_add_f32 v[68:69], v[68:69], s[76:77]
  v_pk_add_f32 v[70:71], v[70:71], s[76:77]
  v_rcp_f32 v64, v64
  v_rcp_f32 v65, v65
  v_rcp_f32 v66, v66
  v_rcp_f32 v67, v67
  v_rcp_f32 v68, v68
  v_rcp_f32 v69, v69
  v_rcp_f32 v70, v70
  v_rcp_f32 v71, v71
  s_waitcnt lgkmcnt(4)
  v_pk_fma_f32 v[64:65], v[72:73], v[64:65], v[48:49]
  v_pk_fma_f32 v[66:67], v[74:75], v[66:67], v[50:51]
  v_pk_fma_f32 v[68:69], v[76:77], v[68:69], v[52:53]
  v_pk_fma_f32 v[70:71], v[78:79], v[70:71], v[54:55]
  v_max_f32 v64, v40, v64
  v_max_f32 v65, v41, v65
  v_max_f32 v66, v42, v66
  v_max_f32 v67, v43, v67
  v_max_f32 v68, v44, v68
  v_max_f32 v69, v45, v69
  v_max_f32 v70, v46, v70
  v_max_f32 v71, v47, v71
  v_cvt_pk_bf16_f32 v64, v64, v65
  v_cvt_pk_bf16_f32 v65, v66, v67
  v_cvt_pk_bf16_f32 v66, v68, v69
  v_cvt_pk_bf16_f32 v67, v70, v71
  buffer_store_dwordx4 v[64:67], v60, s[64:67], s6 offen sc1
  s_cmp_ge_u32 s3, 4
  s_cbranch_scc1 K_DONE
  s_cmp_eq_u32 s3, 3
  s_cselect_b32 exec_hi, 0xff, -1
  s_add_u32 s6, s6, 65536
  s_waitcnt lgkmcnt(2)
  v_pk_add_f32 v[80:81], v[80:81], s[76:77]
  v_pk_add_f32 v[82:83], v[82:83], s[76:77]
  v_pk_add_f32 v[84:85], v[84:85], s[76:77]
  v_pk_add_f32 v[86:87], v[86:87], s[76:77]
  v_rcp_f32 v80, v80
  v_rcp_f32 v81, v81
  v_rcp_f32 v82, v82
  v_rcp_f32 v83, v83
  v_rcp_f32 v84, v84
  v_rcp_f32 v85, v85
  v_rcp_f32 v86, v86
  v_rcp_f32 v87, v87
  s_waitcnt lgkmcnt(0)
  v_pk_fma_f32 v[80:81], v[88:89], v[80:81], v[104:105]
  v_pk_fma_f32 v[82:83], v[90:91], v[82:83], v[106:107]
  v_pk_fma_f32 v[84:85], v[92:93], v[84:85], v[108:109]
  v_pk_fma_f32 v[86:87], v[94:95], v[86:87], v[110:111]
  v_max_f32 v80, v96, v80
  v_max_f32 v81, v97, v81
  v_max_f32 v82, v98, v82
  v_max_f32 v83, v99, v83
  v_max_f32 v84, v100, v84
  v_max_f32 v85, v101, v85
  v_max_f32 v86, v102, v86
  v_max_f32 v87, v103, v87
  v_cvt_pk_bf16_f32 v80, v80, v81
  v_cvt_pk_bf16_f32 v81, v82, v83
  v_cvt_pk_bf16_f32 v82, v84, v85
  v_cvt_pk_bf16_f32 v83, v86, v87
  buffer_store_dwordx4 v[80:83], v60, s[64:67], s6 offen sc1
  s_branch K_DONE
K_PFIX:
  v_cmpx_lt_u32 vcc, 2, v88
  v_min_u32 v80, 35, v80
  v_and_b32 v4, 3, v80
  v_lshrrev_b32 v6, 1, v76
  v_lshl_add_u32 v4, v4, 4, v6
  v_add_u32 v84, 8192, v4
  v_lshrrev_b32 v4, 2, v80
  v_add_u32 v88, -6, v4
  s_mov_b32 exec_lo, -1
  s_mov_b32 exec_hi, 255
  v_cmpx_lt_u32 vcc, 2, v89
  v_min_u32 v81, 35, v81
  v_and_b32 v4, 3, v81
  v_lshrrev_b32 v6, 1, v77
  v_lshl_add_u32 v4, v4, 4, v6
  v_add_u32 v85, 8192, v4
  v_lshrrev_b32 v4, 2, v81
  v_add_u32 v89, -6, v4
  s_mov_b32 exec_lo, -1
  s_mov_b32 exec_hi, 255
  v_cmpx_lt_u32 vcc, 2, v90
  v_min_u32 v82, 35, v82
  v_and_b32 v4, 3, v82
  v_lshrrev_b32 v6, 1, v78
  v_lshl_add_u32 v4, v4, 4, v6
  v_add_u32 v86, 8192, v4
  v_lshrrev_b32 v4, 2, v82
  v_add_u32 v90, -6, v4
  s_mov_b32 exec_lo, -1
  s_mov_b32 exec_hi, 255
  v_cmpx_lt_u32 vcc, 2, v91
  v_min_u32 v83, 35, v83
  v_and_b32 v4, 3, v83
  v_lshrrev_b32 v6, 1, v79
  v_lshl_add_u32 v4, v4, 4, v6
  v_add_u32 v87, 8192, v4
  v_lshrrev_b32 v4, 2, v83
  v_add_u32 v91, -6, v4
  s_mov_b32 exec_lo, -1
  s_mov_b32 exec_hi, 255
  s_branch K_PFB
K_POV:
  ds_read_b128 v[72:75], v57 offset:8192
  s_waitcnt lgkmcnt(0)
  v_and_b32 v75, v75, v42
  buffer_store_dwordx4 v[72:75], v57, s[52:55], s9 offen sc1
  s_branch K_POB
K_RT0:
  s_wqm_b64 exec, vcc
  buffer_load_dwordx4 v[64:67], v43, s[52:55], s40 offen sc1
  s_sub_u32 s11, s11, 1
  s_waitcnt vmcnt(0)
  s_cbranch_scc0 K_RU0
  s_mov_b32 s11, 0
  s_mov_b64 s[82:83], -1
  v_mov_b32 v67, v42
K_RU0:
  s_mov_b64 exec, -1
  s_branch K_C0
K_S0:
  v_cmp_ne_u32_sdwa vcc, v67, v42 src0_sel:BYTE_3 src1_sel:BYTE_3
  s_cbranch_vccnz K_RT0
  v_cmp_ne_u32_sdwa vcc, v67, v42 src0_sel:BYTE_2 src1_sel:BYTE_2
  s_and_b64 s[8:9], vcc, s[50:51]
  s_cbranch_scc1 K_SB0
  s_or_b64 s[50:51], s[50:51], vcc
  s_mov_b64 exec, vcc
  v_lshlrev_b32_sdwa v47, 4, v67 dst_sel:DWORD dst_unused:UNUSED_PAD src0_sel:DWORD src1_sel:BYTE_2
  v_mov_b32 v46, v66
  v_and_or_b32 v47, v66, 12, v47
  ds_add_rtn_u32 v48, v47, v2 offset:0
K_SC0:
  s_and_b64 s[8:9], exec, s[48:49]
  s_cbranch_scc0 K_SE0
  s_wqm_b64 s[8:9], s[8:9]
  s_lshr_b64 s[8:9], s[8:9], 4
  s_and_b64 s[12:13], s[8:9], s[56:57]
  s_or_b64 s[82:83], s[82:83], s[12:13]
  s_andn2_b64 exec, s[8:9], s[56:57]
  s_or_b64 s[56:57], s[56:57], s[8:9]
  v_add_u32 v44, 0, v45
  buffer_load_dwordx4 v[96:99], v44, s[52:55], s58 offen sc1
K_SE0:
  s_mov_b64 exec, -1
  s_branch K_D0
K_SB0:
  v_lshlrev_b32_sdwa v37, 4, v67 dst_sel:DWORD dst_unused:UNUSED_PAD src0_sel:DWORD src1_sel:BYTE_2
  s_nop 0
  v_and_or_b32 v37, v66, 12, v37
  s_mov_b64 exec, vcc
  s_bitset1_b32 s15, 0
  ds_add_rtn_u32 v10, v37, v2 offset:0
  s_branch K_SC0
K_RT1:
  s_wqm_b64 exec, vcc
  buffer_load_dwordx4 v[68:71], v43, s[52:55], s41 offen sc1
  s_sub_u32 s11, s11, 1
  s_waitcnt vmcnt(0)
  s_cbranch_scc0 K_RU1
  s_mov_b32 s11, 0
  s_mov_b64 s[82:83], -1
  v_mov_b32 v71, v42
K_RU1:
  s_mov_b64 exec, -1
  s_branch K_C1
K_S1:
  v_cmp_ne_u32_sdwa vcc, v71, v42 src0_sel:BYTE_3 src1_sel:BYTE_3
  s_cbranch_vccnz K_RT1
  v_cmp_ne_u32_sdwa vcc, v71, v42 src0_sel:BYTE_2 src1_sel:BYTE_2
  s_and_b64 s[8:9], vcc, s[50:51]
  s_cbranch_scc1 K_SB1
  s_or_b64 s[50:51], s[50:51], vcc
  s_mov_b64 exec, vcc
  v_lshlrev_b32_sdwa v47, 4, v71 dst_sel:DWORD dst_unused:UNUSED_PAD src0_sel:DWORD src1_sel:BYTE_2
  v_mov_b32 v46, v70
  v_and_or_b32 v47, v70, 12, v47
  ds_add_rtn_u32 v48, v47, v2 offset:0
K_SC1:
  s_and_b64 s[8:9], exec, s[48:49]
  s_cbranch_scc0 K_SE1
  s_wqm_b64 s[8:9], s[8:9]
  s_and_b64 s[12:13], s[8:9], s[56:57]
  s_or_b64 s[82:83], s[82:83], s[12:13]
  s_andn2_b64 exec, s[8:9], s[56:57]
  s_or_b64 s[56:57], s[56:57], s[8:9]
  v_add_u32 v44, 98304, v45
  buffer_load_dwordx4 v[96:99], v44, s[52:55], s58 offen sc1
K_SE1:
  s_mov_b64 exec, -1
  s_branch K_D1
K_SB1:
  v_lshlrev_b32_sdwa v40, 4, v71 dst_sel:DWORD dst_unused:UNUSED_PAD src0_sel:DWORD src1_sel:BYTE_2
  s_nop 0
  v_and_or_b32 v40, v70, 12, v40
  s_mov_b64 exec, vcc
  s_bitset1_b32 s15, 1
  ds_add_rtn_u32 v13, v40, v2 offset:0
  s_branch K_SC1
K_RT2:
  s_wqm_b64 exec, vcc
  buffer_load_dwordx4 v[72:75], v43, s[52:55], s42 offen sc1
  s_sub_u32 s11, s11, 1
  s_waitcnt vmcnt(0)
  s_cbranch_scc0 K_RU2
  s_mov_b32 s11, 0
  s_mov_b64 s[82:83], -1
  v_mov_b32 v75, v42
K_RU2:
  s_mov_b64 exec, -1
  s_branch K_C2
K_S2:
  v_cmp_ne_u32_sdwa vcc, v75, v42 src0_sel:BYTE_3 src1_sel:BYTE_3
  s_cbranch_vccnz K_RT2
  v_cmp_ne_u32_sdwa vcc, v75, v42 src0_sel:BYTE_2 src1_sel:BYTE_2
  s_and_b64 s[8:9], vcc, s[50:51]
  s_cbranch_scc1 K_SB2
  s_or_b64 s[50:51], s[50:51], vcc
  s_mov_b64 exec, vcc
  v_lshlrev_b32_sdwa v47, 4, v75 dst_sel:DWORD dst_unused:UNUSED_PAD src0_sel:DWORD src1_sel:BYTE_2
  v_mov_b32 v46, v74
  v_and_or_b32 v47, v74, 12, v47
  ds_add_rtn_u32 v48, v47, v2 offset:0
K_SC2:
  s_and_b64 s[8:9], exec, s[48:49]
  s_cbranch_scc0 K_SE2
  s_wqm_b64 s[8:9], s[8:9]
  s_lshr_b64 s[8:9], s[8:9], 4
  s_and_b64 s[12:13], s[8:9], s[56:57]
  s_or_b64 s[82:83], s[82:83], s[12:13]
  s_andn2_b64 exec, s[8:9], s[56:57]
  s_or_b64 s[56:57], s[56:57], s[8:9]
  v_add_u32 v44, 196608, v45
  buffer_load_dwordx4 v[96:99], v44, s[52:55], s58 offen sc1
K_SE2:
  s_mov_b64 exec, -1
  s_branch K_D2
K_SB2:
  v_lshlrev_b32_sdwa v101, 4, v75 dst_sel:DWORD dst_unused:UNUSED_PAD src0_sel:DWORD src1_sel:BYTE_2
  s_nop 0
  v_and_or_b32 v101, v74, 12, v101
  s_mov_b64 exec, vcc
  s_bitset1_b32 s15, 2
  ds_add_rtn_u32 v16, v101, v2 offset:0
  s_branch K_SC2
K_RT3:
  s_wqm_b64 exec, vcc
  buffer_load_dwordx4 v[76:79], v43, s[52:55], s43 offen sc1
  s_sub_u32 s11, s11, 1
  s_waitcnt vmcnt(0)
  s_cbranch_scc0 K_RU3
  s_mov_b32 s11, 0
  s_mov_b64 s[82:83], -1
  v_mov_b32 v79, v42
K_RU3:
  s_mov_b64 exec, -1
  s_branch K_C3
K_S3:
  v_cmp_ne_u32_sdwa vcc, v79, v42 src0_sel:BYTE_3 src1_sel:BYTE_3
  s_cbranch_vccnz K_RT3
  v_cmp_ne_u32_sdwa vcc, v79, v42 src0_sel:BYTE_2 src1_sel:BYTE_2
  s_and_b64 s[8:9], vcc, s[50:51]
  s_cbranch_scc1 K_SB3
  s_or_b64 s[50:51], s[50:51], vcc
  s_mov_b64 exec, vcc
  v_lshlrev_b32_sdwa v47, 4, v79 dst_sel:DWORD dst_unused:UNUSED_PAD src0_sel:DWORD src1_sel:BYTE_2
  v_mov_b32 v46, v78
  v_and_or_b32 v47, v78, 12, v47
  ds_add_rtn_u32 v48, v47, v2 offset:0
K_SC3:
  s_and_b64 s[8:9], exec, s[48:49]
  s_cbranch_scc0 K_SE3
  s_wqm_b64 s[8:9], s[8:9]
  s_and_b64 s[12:13], s[8:9], s[56:57]
  s_or_b64 s[82:83], s[82:83], s[12:13]
  s_andn2_b64 exec, s[8:9], s[56:57]
  s_or_b64 s[56:57], s[56:57], s[8:9]
  v_add_u32 v44, 294912, v45
  buffer_load_dwordx4 v[96:99], v44, s[52:55], s58 offen sc1
K_SE3:
  s_mov_b64 exec, -1
  s_branch K_D3
K_SB3:
  v_lshlrev_b32_sdwa v104, 4, v79 dst_sel:DWORD dst_unused:UNUSED_PAD src0_sel:DWORD src1_sel:BYTE_2
  s_nop 0
  v_and_or_b32 v104, v78, 12, v104
  s_mov_b64 exec, vcc
  s_bitset1_b32 s15, 3
  ds_add_rtn_u32 v19, v104, v2 offset:0
  s_branch K_SC3
K_RT4:
  s_wqm_b64 exec, vcc
  buffer_load_dwordx4 v[80:83], v43, s[52:55], s44 offen sc1
  s_sub_u32 s11, s11, 1
  s_waitcnt vmcnt(0)
  s_cbranch_scc0 K_RU4
  s_mov_b32 s11, 0
  s_mov_b64 s[82:83], -1
  v_mov_b32 v83, v42
K_RU4:
  s_mov_b64 exec, -1
  s_branch K_C4
K_S4:
  v_cmp_ne_u32_sdwa vcc, v83, v42 src0_sel:BYTE_3 src1_sel:BYTE_3
  s_cbranch_vccnz K_RT4
  v_cmp_ne_u32_sdwa vcc, v83, v42 src0_sel:BYTE_2 src1_sel:BYTE_2
  s_and_b64 s[8:9], vcc, s[50:51]
  s_cbranch_scc1 K_SB4
  s_or_b64 s[50:51], s[50:51], vcc
  s_mov_b64 exec, vcc
  v_lshlrev_b32_sdwa v47, 4, v83 dst_sel:DWORD dst_unused:UNUSED_PAD src0_sel:DWORD src1_sel:BYTE_2
  v_mov_b32 v46, v82
  v_and_or_b32 v47, v82, 12, v47
  ds_add_rtn_u32 v48, v47, v2 offset:0
K_SC4:
  s_and_b64 s[8:9], exec, s[48:49]
  s_cbranch_scc0 K_SE4
  s_wqm_b64 s[8:9], s[8:9]
  s_lshr_b64 s[8:9], s[8:9], 4
  s_and_b64 s[12:13], s[8:9], s[56:57]
  s_or_b64 s[82:83], s[82:83], s[12:13]
  s_andn2_b64 exec, s[8:9], s[56:57]
  s_or_b64 s[56:57], s[56:57], s[8:9]
  v_add_u32 v44, 393216, v45
  buffer_load_dwordx4 v[96:99], v44, s[52:55], s58 offen sc1
K_SE4:
  s_mov_b64 exec, -1
  s_branch K_D4
K_SB4:
  v_lshlrev_b32_sdwa v107, 4, v83 dst_sel:DWORD dst_unused:UNUSED_PAD src0_sel:DWORD src1_sel:BYTE_2
  s_nop 0
  v_and_or_b32 v107, v82, 12, v107
  s_mov_b64 exec, vcc
  s_bitset1_b32 s15, 4
  ds_add_rtn_u32 v22, v107, v2 offset:0
  s_branch K_SC4
K_RT5:
  s_wqm_b64 exec, vcc
  buffer_load_dwordx4 v[84:87], v43, s[52:55], s45 offen sc1
  s_sub_u32 s11, s11, 1
  s_waitcnt vmcnt(0)
  s_cbranch_scc0 K_RU5
  s_mov_b32 s11, 0
  s_mov_b64 s[82:83], -1
  v_mov_b32 v87, v42
K_RU5:
  s_mov_b64 exec, -1
  s_branch K_C5
K_S5:
  v_cmp_ne_u32_sdwa vcc, v87, v42 src0_sel:BYTE_3 src1_sel:BYTE_3
  s_cbranch_vccnz K_RT5
  v_cmp_ne_u32_sdwa vcc, v87, v42 src0_sel:BYTE_2 src1_sel:BYTE_2
  s_and_b64 s[8:9], vcc, s[50:51]
  s_cbranch_scc1 K_SB5
  s_or_b64 s[50:51], s[50:51], vcc
  s_mov_b64 exec, vcc
  v_lshlrev_b32_sdwa v47, 4, v87 dst_sel:DWORD dst_unused:UNUSED_PAD src0_sel:DWORD src1_sel:BYTE_2
  v_mov_b32 v46, v86
  v_and_or_b32 v47, v86, 12, v47
  ds_add_rtn_u32 v48, v47, v2 offset:0
K_SC5:
  s_and_b64 s[8:9], exec, s[48:49]
  s_cbranch_scc0 K_SE5
  s_wqm_b64 s[8:9], s[8:9]
  s_and_b64 s[12:13], s[8:9], s[56:57]
  s_or_b64 s[82:83], s[82:83], s[12:13]
  s_andn2_b64 exec, s[8:9], s[56:57]
  s_or_b64 s[56:57], s[56:57], s[8:9]
  v_add_u32 v44, 491520, v45
  buffer_load_dwordx4 v[96:99], v44, s[52:55], s58 offen sc1
K_SE5:
  s_mov_b64 exec, -1
  s_branch K_D5
K_SB5:
  v_lshlrev_b32_sdwa v110, 4, v87 dst_sel:DWORD dst_unused:UNUSED_PAD src0_sel:DWORD src1_sel:BYTE_2
  s_nop 0
  v_and_or_b32 v110, v86, 12, v110
  s_mov_b64 exec, vcc
  s_bitset1_b32 s15, 5
  ds_add_rtn_u32 v25, v110, v2 offset:0
  s_branch K_SC5
K_RT6:
  s_wqm_b64 exec, vcc
  buffer_load_dwordx4 v[88:91], v43, s[52:55], s46 offen sc1
  s_sub_u32 s11, s11, 1
  s_waitcnt vmcnt(0)
  s_cbranch_scc0 K_RU6
  s_mov_b32 s11, 0
  s_mov_b64 s[82:83], -1
  v_mov_b32 v91, v42
K_RU6:
  s_mov_b64 exec, -1
  s_branch K_C6
K_S6:
  v_cmp_ne_u32_sdwa vcc, v91, v42 src0_sel:BYTE_3 src1_sel:BYTE_3
  s_cbranch_vccnz K_RT6
  v_cmp_ne_u32_sdwa vcc, v91, v42 src0_sel:BYTE_2 src1_sel:BYTE_2
  s_and_b64 s[8:9], vcc, s[50:51]
  s_cbranch_scc1 K_SB6
  s_or_b64 s[50:51], s[50:51], vcc
  s_mov_b64 exec, vcc
  v_lshlrev_b32_sdwa v47, 4, v91 dst_sel:DWORD dst_unused:UNUSED_PAD src0_sel:DWORD src1_sel:BYTE_2
  v_mov_b32 v46, v90
  v_and_or_b32 v47, v90, 12, v47
  ds_add_rtn_u32 v48, v47, v2 offset:0
K_SC6:
  s_and_b64 s[8:9], exec, s[48:49]
  s_cbranch_scc0 K_SE6
  s_wqm_b64 s[8:9], s[8:9]
  s_lshr_b64 s[8:9], s[8:9], 4
  s_and_b64 s[12:13], s[8:9], s[56:57]
  s_or_b64 s[82:83], s[82:83], s[12:13]
  s_andn2_b64 exec, s[8:9], s[56:57]
  s_or_b64 s[56:57], s[56:57], s[8:9]
  v_add_u32 v44, 589824, v45
  buffer_load_dwordx4 v[96:99], v44, s[52:55], s58 offen sc1
K_SE6:
  s_mov_b64 exec, -1
  s_branch K_D6
K_SB6:
  v_lshlrev_b32_sdwa v121, 4, v91 dst_sel:DWORD dst_unused:UNUSED_PAD src0_sel:DWORD src1_sel:BYTE_2
  s_nop 0
  v_and_or_b32 v121, v90, 12, v121
  s_mov_b64 exec, vcc
  s_bitset1_b32 s15, 6
  ds_add_rtn_u32 v28, v121, v2 offset:0
  s_branch K_SC6
K_RT7:
  s_wqm_b64 exec, vcc
  buffer_load_dwordx4 v[92:95], v43, s[52:55], s47 offen sc1
  s_sub_u32 s11, s11, 1
  s_waitcnt vmcnt(0)
  s_cbranch_scc0 K_RU7
  s_mov_b32 s11, 0
  s_mov_b64 s[82:83], -1
  v_mov_b32 v95, v42
K_RU7:
  s_mov_b64 exec, -1
  s_branch K_C7
K_S7:
  v_cmp_ne_u32_sdwa vcc, v95, v42 src0_sel:BYTE_3 src1_sel:BYTE_3
  s_cbranch_vccnz K_RT7
  v_cmp_ne_u32_sdwa vcc, v95, v42 src0_sel:BYTE_2 src1_sel:BYTE_2
  s_and_b64 s[8:9], vcc, s[50:51]
  s_cbranch_scc1 K_SB7
  s_or_b64 s[50:51], s[50:51], vcc
  s_mov_b64 exec, vcc
  v_lshlrev_b32_sdwa v47, 4, v95 dst_sel:DWORD dst_unused:UNUSED_PAD src0_sel:DWORD src1_sel:BYTE_2
  v_mov_b32 v46, v94
  v_and_or_b32 v47, v94, 12, v47
  ds_add_rtn_u32 v48, v47, v2 offset:0
K_SC7:
  s_and_b64 s[8:9], exec, s[48:49]
  s_cbranch_scc0 K_SE7
  s_wqm_b64 s[8:9], s[8:9]
  s_and_b64 s[12:13], s[8:9], s[56:57]
  s_or_b64 s[82:83], s[82:83], s[12:13]
  s_andn2_b64 exec, s[8:9], s[56:57]
  s_or_b64 s[56:57], s[56:57], s[8:9]
  v_add_u32 v44, 688128, v45
  buffer_load_dwordx4 v[96:99], v44, s[52:55], s58 offen sc1
K_SE7:
  s_mov_b64 exec, -1
  s_branch K_D7
K_SB7:
  v_lshlrev_b32_sdwa v124, 4, v95 dst_sel:DWORD dst_unused:UNUSED_PAD src0_sel:DWORD src1_sel:BYTE_2
  s_nop 0
  v_and_or_b32 v124, v94, 12, v124
  s_mov_b64 exec, vcc
  s_bitset1_b32 s15, 7
  ds_add_rtn_u32 v31, v124, v2 offset:0
  s_branch K_SC7
K_RT8:
  s_wqm_b64 exec, vcc
  buffer_load_dwordx4 v[96:99], v44, s[52:55], s58 offen sc1
  s_sub_u32 s11, s11, 1
  s_waitcnt vmcnt(0)
  s_cbranch_scc0 K_RU8
  s_mov_b32 s11, 0
  s_mov_b64 s[82:83], -1
  v_mov_b32 v99, v42
K_RU8:
  s_mov_b64 exec, -1
  s_branch K_C8
K_SX:
  s_bitcmp1_b32 s15, 0
  s_cbranch_scc0 K_SX0
  ds_read_b32 v37, v37 offset:0
  s_waitcnt lgkmcnt(0)
  v_lshl_add_u32 v37, v10, 4, v37
  ds_write_b32 v37, v66
K_SX0:
  s_bitcmp1_b32 s15, 1
  s_cbranch_scc0 K_SX1
  ds_read_b32 v40, v40 offset:0
  s_waitcnt lgkmcnt(0)
  v_lshl_add_u32 v40, v13, 4, v40
  ds_write_b32 v40, v70
K_SX1:
  s_bitcmp1_b32 s15, 2
  s_cbranch_scc0 K_SX2
  ds_read_b32 v101, v101 offset:0
  s_waitcnt lgkmcnt(0)
  v_lshl_add_u32 v101, v16, 4, v101
  ds_write_b32 v101, v74
K_SX2:
  s_bitcmp1_b32 s15, 3
  s_cbranch_scc0 K_SX3
  ds_read_b32 v104, v104 offset:0
  s_waitcnt lgkmcnt(0)
  v_lshl_add_u32 v104, v19, 4, v104
  ds_write_b32 v104, v78
K_SX3:
  s_bitcmp1_b32 s15, 4
  s_cbranch_scc0 K_SX4
  ds_read_b32 v107, v107 offset:0
  s_waitcnt lgkmcnt(0)
  v_lshl_add_u32 v107, v22, 4, v107
  ds_write_b32 v107, v82
K_SX4:
  s_bitcmp1_b32 s15, 5
  s_cbranch_scc0 K_SX5
  ds_read_b32 v110, v110 offset:0
  s_waitcnt lgkmcnt(0)
  v_lshl_add_u32 v110, v25, 4, v110
  ds_write_b32 v110, v86
K_SX5:
  s_bitcmp1_b32 s15, 6
  s_cbranch_scc0 K_SX6
  ds_read_b32 v121, v121 offset:0
  s_waitcnt lgkmcnt(0)
  v_lshl_add_u32 v121, v28, 4, v121
  ds_write_b32 v121, v90
K_SX6:
  s_bitcmp1_b32 s15, 7
  s_cbranch_scc0 K_SX7
  ds_read_b32 v124, v124 offset:0
  s_waitcnt lgkmcnt(0)
  v_lshl_add_u32 v124, v31, 4, v124
  ds_write_b32 v124, v94
K_SX7:
  s_cmp_eq_u64 s[56:57], 0
  s_cbranch_scc1 K_SW8
  ds_read_b32 v125, v125 offset:0
  ds_read_b32 v126, v126 offset:0
  ds_read_b32 v127, v127 offset:0
  s_waitcnt lgkmcnt(1)
  v_lshl_add_u32 v125, v32, 4, v125
  ds_write_b32 v125, v96
  v_lshl_add_u32 v126, v33, 4, v126
  ds_write_b32 v126, v97
  s_waitcnt lgkmcnt(2)
  v_lshl_add_u32 v127, v34, 4, v127
  ds_write_b32 v127, v98
  s_branch K_SW8
K_XW13:
  s_mov_b32 s80, 0x400000
K_XS13:
  ds_read_b32 v0, v3 offset:16160
  s_waitcnt lgkmcnt(0)
  v_readfirstlane_b32 s8, v0
  s_cmp_ge_i32 s8, 12
  s_cbranch_scc1 K_XS13_D
  s_sub_u32 s80, s80, 1
  s_cbranch_scc0 K_XS13
K_XS13_D:
  ds_read_b128 v[24:27], v2 offset:24576
  v_xor_b32 v2, 64, v2
  ds_read_b128 v[28:31], v2 offset:24576
  v_xor_b32 v2, 192, v2
  ds_read_b128 v[32:35], v2 offset:24576
  v_xor_b32 v2, 64, v2
  ds_read_b128 v[36:39], v2 offset:24576
  v_xor_b32 v2, 192, v2
  s_waitcnt lgkmcnt(0)
  s_branch K_XK13
K_XW14:
  s_mov_b32 s80, 0x400000
K_XS14:
  ds_read_b32 v0, v3 offset:16160
  s_waitcnt lgkmcnt(0)
  v_readfirstlane_b32 s8, v0
  s_cmp_ge_i32 s8, 13
  s_cbranch_scc1 K_XS14_D
  s_sub_u32 s80, s80, 1
  s_cbranch_scc0 K_XS14
K_XS14_D:
  ds_read_b128 v[24:27], v2 offset:32768
  v_xor_b32 v2, 64, v2
  ds_read_b128 v[28:31], v2 offset:32768
  v_xor_b32 v2, 192, v2
  ds_read_b128 v[32:35], v2 offset:32768
  v_xor_b32 v2, 64, v2
  ds_read_b128 v[36:39], v2 offset:32768
  v_xor_b32 v2, 192, v2
  s_waitcnt lgkmcnt(0)
  s_branch K_XK14
K_XW15:
  s_mov_b32 s80, 0x400000
K_XS15:
  ds_read_b32 v0, v3 offset:16160
  s_waitcnt lgkmcnt(0)
  v_readfirstlane_b32 s8, v0
  s_cmp_ge_i32 s8, 14
  s_cbranch_scc1 K_XS15_D
  s_sub_u32 s80, s80, 1
  s_cbranch_scc0 K_XS15
K_XS15_D:
  ds_read_b128 v[24:27], v2 offset:40960
  v_xor_b32 v2, 64, v2
  ds_read_b128 v[28:31], v2 offset:40960
  v_xor_b32 v2, 192, v2
  ds_read_b128 v[32:35], v2 offset:40960
  v_xor_b32 v2, 64, v2
  ds_read_b128 v[36:39], v2 offset:40960
  v_xor_b32 v2, 192, v2
  s_waitcnt lgkmcnt(0)
  s_branch K_XK15
K_XW16:
  s_mov_b32 s80, 0x400000
K_XS16:
  ds_read_b32 v0, v3 offset:16160
  s_waitcnt lgkmcnt(0)
  v_readfirstlane_b32 s8, v0
  s_cmp_ge_i32 s8, 15
  s_cbranch_scc1 K_XS16_D
  s_sub_u32 s80, s80, 1
  s_cbranch_scc0 K_XS16
K_XS16_D:
  ds_read_b128 v[24:27], v2 offset:49152
  v_xor_b32 v2, 64, v2
  ds_read_b128 v[28:31], v2 offset:49152
  v_xor_b32 v2, 192, v2
  ds_read_b128 v[32:35], v2 offset:49152
  v_xor_b32 v2, 64, v2
  ds_read_b128 v[36:39], v2 offset:49152
  v_xor_b32 v2, 192, v2
  s_waitcnt lgkmcnt(0)
  s_branch K_XK16
K_XW17:
  s_mov_b32 s80, 0x400000
K_XS17:
  ds_read_b32 v0, v3 offset:16160
  s_waitcnt lgkmcnt(0)
  v_readfirstlane_b32 s8, v0
  s_cmp_ge_i32 s8, 16
  s_cbranch_scc1 K_XS17_D
  s_sub_u32 s80, s80, 1
  s_cbranch_scc0 K_XS17
K_XS17_D:
  ds_read_b128 v[24:27], v2 offset:57344
  v_xor_b32 v2, 64, v2
  ds_read_b128 v[28:31], v2 offset:57344
  v_xor_b32 v2, 192, v2
  ds_read_b128 v[32:35], v2 offset:57344
  v_xor_b32 v2, 64, v2
  ds_read_b128 v[36:39], v2 offset:57344
  v_xor_b32 v2, 192, v2
  s_waitcnt lgkmcnt(0)
  s_branch K_XK17
K_XW18:
  s_mov_b32 s80, 0x400000
K_XS18:
  ds_read_b32 v0, v3 offset:16160
  s_waitcnt lgkmcnt(0)
  v_readfirstlane_b32 s8, v0
  s_cmp_ge_i32 s8, 17
  s_cbranch_scc1 K_XS18_D
  s_sub_u32 s80, s80, 1
  s_cbranch_scc0 K_XS18
K_XS18_D:
  ds_read_b128 v[24:27], v2 offset:0
  v_xor_b32 v2, 64, v2
  ds_read_b128 v[28:31], v2 offset:0
  v_xor_b32 v2, 192, v2
  ds_read_b128 v[32:35], v2 offset:0
  v_xor_b32 v2, 64, v2
  ds_read_b128 v[36:39], v2 offset:0
  v_xor_b32 v2, 192, v2
  s_waitcnt lgkmcnt(0)
  s_branch K_XK18
K_XW19:
  s_mov_b32 s80, 0x400000
K_XS19:
  ds_read_b32 v0, v3 offset:16160
  s_waitcnt lgkmcnt(0)
  v_readfirstlane_b32 s8, v0
  s_cmp_ge_i32 s8, 18
  s_cbranch_scc1 K_XS19_D
  s_sub_u32 s80, s80, 1
  s_cbranch_scc0 K_XS19
K_XS19_D:
  ds_read_b128 v[24:27], v2 offset:8192
  v_xor_b32 v2, 64, v2
  ds_read_b128 v[28:31], v2 offset:8192
  v_xor_b32 v2, 192, v2
  ds_read_b128 v[32:35], v2 offset:8192
  v_xor_b32 v2, 64, v2
  ds_read_b128 v[36:39], v2 offset:8192
  v_xor_b32 v2, 192, v2
  s_waitcnt lgkmcnt(0)
  s_branch K_XK19
K_WC2W:
  s_mov_b32 s80, 0x400000
K_WC2X:
  ds_read_b32 v23, v3 offset:16168
  s_waitcnt lgkmcnt(0)
  v_readfirstlane_b32 s8, v23
  s_cmp_ge_u32 s8, 4
  s_cbranch_scc1 K_WC2X_D
  s_sub_u32 s80, s80, 1
  s_cbranch_scc0 K_WC2X
K_WC2X_D:
  s_branch K_WC2K
K_PA13:
  s_cmp_lg_u32 s3, 13
  s_cbranch_scc1 K_PAR
  s_setprio 3
  s_branch K_PAR
K_SLOW:
  s_setprio 0
  s_load_dwordx2 s[16:17], s[0:1], 24
  s_load_dwordx2 s[20:21], s[0:1], 16
  s_load_dwordx2 s[24:25], s[0:1], 8
  s_waitcnt vmcnt(0) lgkmcnt(0)
  s_barrier
  v_lshlrev_b32 v37, 2, v1
  ds_read_b32 v36, v37 offset:2560
  v_mov_b32 v24, 0
  v_mov_b32 v25, 0
  v_mov_b32 v26, 0
  v_mov_b32 v27, 0
  v_lshlrev_b32 v2, 4, v1
  s_lshl_b32 s8, s3, 10
  v_add_u32 v2, s8, v2
  s_mov_b32 s10, 6
K_SZ:
  v_min_u32 v4, 82880, v2
  ds_write_b128 v4, v[24:27] offset:16384
  v_add_u32 v2, 16384, v2
  s_sub_u32 s10, s10, 1
  s_cmp_lg_u32 s10, 0
  s_cbranch_scc1 K_SZ
  s_mov_b32 s18, 640000
  s_mov_b32 s19, 0x20000
  s_mov_b32 s22, 640000
  s_mov_b32 s23, 0x20000
  s_mov_b32 s26, 320000
  s_mov_b32 s27, 0x20000
  s_waitcnt lgkmcnt(0)
  s_barrier
  s_mul_i32 s8, s5, 157
  s_sub_u32 s9, 10000, s8
  s_min_u32 s9, s9, 157
  s_mul_i32 s10, s3, 10000
  s_add_u32 s11, s10, 10000
  s_mul_i32 s14, s4, 2686976
K_SO:
  v_add_u32 v2, s10, v1
  v_cmp_gt_u32 vcc, s11, v2
  v_lshlrev_b32 v3, 2, v2
  v_lshlrev_b32 v2, 1, v2
  buffer_load_dword v64, v3, s[16:19], 0 offen
  buffer_load_dword v65, v3, s[20:23], 0 offen
  buffer_load_ushort v66, v2, s[24:27], 0 offen
  s_mov_b64 s[28:29], vcc
  s_waitcnt vmcnt(0)
  v_subrev_u32 v64, s8, v64
  v_cmp_gt_u32 vcc, s9, v64
  v_lshlrev_b32 v65, 8, v65
  v_lshlrev_b32 v66, 16, v66
  s_and_b64 s[28:29], s[28:29], vcc
  s_cbranch_scc0 K_SN
K_SI:
  s_ff1_i32_b64 s12, s[28:29]
  s_bitset0_b64 s[28:29], s12
  v_readlane_b32 s30, v64, s12
  v_readlane_b32 s31, v65, s12
  v_readlane_b32 s32, v66, s12
  s_add_u32 s31, s31, s14
  s_mul_i32 s33, s30, 272
  s_add_u32 s33, s33, 99280
  s_mul_i32 s30, s30, 528
  v_add_u32 v67, s30, v37
  v_add_u32 v69, s33, v37
  s_nop 3
  buffer_load_dword v68, v37, s[52:55], s31 offen sc1
  ds_read_b32 v69, v69
  s_waitcnt vmcnt(0) lgkmcnt(0)
  v_add_f32 v69, 0x40000000, v69
  v_fma_f32 v69, s32, v36, v69
  v_add_f32 v69, v69, v68
  v_exp_f32 v69, v69
  v_lshlrev_b32 v68, 16, v68
  v_add_f32 v69, 1.0, v69
  v_rcp_f32 v69, v69
  v_mul_f32 v68, 0x37800000, v68
  v_mul_f32 v68, v68, v69
  ds_add_f32 v67, v69 offset:16384
  ds_add_f32 v67, v68 offset:16640
  s_cmp_lg_u64 s[28:29], 0
  s_cbranch_scc1 K_SI
K_SN:
  s_add_u32 s10, s10, 64
  s_cmp_lt_u32 s10, s11
  s_cbranch_scc1 K_SO
  s_load_dwordx2 s[40:41], s[0:1], 0
  v_lshrrev_b32 v8, 3, v1
  v_lshl_add_u32 v8, s3, 3, v8
  v_and_b32 v9, 7, v1
  v_mul_u32_u24 v59, 528, v8
  v_lshl_add_u32 v59, v9, 5, v59
  v_and_b32 v10, 7, v8
  v_xor_b32 v10, v10, v9
  v_lshlrev_b32 v10, 4, v10
  v_lshl_add_u32 v61, v8, 7, v10
  v_add_u32 v61, 142800, v61
  v_lshl_add_u32 v9, s4, 3, v9
  v_lshlrev_b32 v60, 9, v8
  v_lshl_add_u32 v60, v9, 4, v60
  s_mov_b32 s42, 5120000
  s_mov_b32 s43, 0x20000
  s_add_u32 s8, s6, 65536
  s_waitcnt lgkmcnt(0)
  buffer_load_dwordx4 v[112:115], v60, s[40:43], s6 offen
  buffer_load_dwordx4 v[116:119], v60, s[40:43], s8 offen
  s_waitcnt vmcnt(0)
  ds_read_b128 v[64:67], v61
  ds_read_b128 v[68:71], v61 offset:16384
  v_lshlrev_b32 v40, 16, v112
  v_and_b32 v41, s78, v112
  v_lshlrev_b32 v42, 16, v113
  v_and_b32 v43, s78, v113
  v_lshlrev_b32 v44, 16, v114
  v_and_b32 v45, s78, v114
  v_lshlrev_b32 v46, 16, v115
  v_and_b32 v47, s78, v115
  s_waitcnt lgkmcnt(1)
  v_lshlrev_b32 v48, 16, v64
  v_and_b32 v49, s78, v64
  v_lshlrev_b32 v50, 16, v65
  v_and_b32 v51, s78, v65
  v_lshlrev_b32 v52, 16, v66
  v_and_b32 v53, s78, v66
  v_lshlrev_b32 v54, 16, v67
  v_and_b32 v55, s78, v67
  v_pk_add_f32 v[48:49], v[48:49], v[40:41]
  v_pk_add_f32 v[50:51], v[50:51], v[42:43]
  v_pk_add_f32 v[52:53], v[52:53], v[44:45]
  v_pk_add_f32 v[54:55], v[54:55], v[46:47]
  s_cmp_ge_u32 s3, 4
  s_cbranch_scc1 K_PF0
  s_waitcnt vmcnt(0)
  v_lshlrev_b32 v96, 16, v116
  v_and_b32 v97, s78, v116
  v_lshlrev_b32 v98, 16, v117
  v_and_b32 v99, s78, v117
  v_lshlrev_b32 v100, 16, v118
  v_and_b32 v101, s78, v118
  v_lshlrev_b32 v102, 16, v119
  v_and_b32 v103, s78, v119
  s_waitcnt lgkmcnt(0)
  v_lshlrev_b32 v104, 16, v68
  v_and_b32 v105, s78, v68
  v_lshlrev_b32 v106, 16, v69
  v_and_b32 v107, s78, v69
  v_lshlrev_b32 v108, 16, v70
  v_and_b32 v109, s78, v70
  v_lshlrev_b32 v110, 16, v71
  v_and_b32 v111, s78, v71
  v_pk_add_f32 v[104:105], v[104:105], v[96:97]
  v_pk_add_f32 v[106:107], v[106:107], v[98:99]
  v_pk_add_f32 v[108:109], v[108:109], v[100:101]
  v_pk_add_f32 v[110:111], v[110:111], v[102:103]
K_PF0:
  s_waitcnt lgkmcnt(0)
  s_branch K_FIN0
K_CODE_END:
.section .rodata,"a"
.p2align 6
.amdhsa_kernel standalone__edge_featured_mpnn_gatedgcn__graph_kernel
  .amdhsa_next_free_vgpr 128
  .amdhsa_next_free_sgpr 102
  .amdhsa_accum_offset 128
  .amdhsa_group_segment_fixed_size 0
  .amdhsa_kernarg_size 96
  .amdhsa_user_sgpr_count 2
  .amdhsa_user_sgpr_kernarg_segment_ptr 1
  .amdhsa_system_sgpr_workgroup_id_x 1
.end_amdhsa_kernel
```
